```python
import torch

def _softmax(x, axis=-1):
    return torch.softmax(x, dim=axis)

def _gelu(x):
    return torch.nn.functional.gelu(x, approximate='tanh')

def _silu(x):
    return torch.nn.functional.silu(x)

def _sigmoid(x):
    return torch.sigmoid(x)

def _layernorm(x, axis=-1, eps=1e-05):
    m = x.mean(dim=axis, keepdim=True)
    v = x.var(dim=axis, keepdim=True, unbiased=False)
    return (x - m) / torch.sqrt(v + eps)

def _scatter_add(tgt, idx, src, axis=0):
    return tgt.clone().index_add_(axis, idx, src)

def _segment_sum(src, seg, n):
    out = torch.zeros((n,) + src.shape[1:], dtype=src.dtype)
    return out.index_add_(0, seg, src)

def _pad(x, pw):
    flat = tuple((v for pair in reversed(pw) for v in pair))
    return torch.nn.functional.pad(x, flat)
kernel_name = 'adaLN_cond__sliding_block__glu_gated_geglu__prompt'

def setup_inputs():

    _w = lambda a: (lambda t: t.to(torch.bfloat16) if t.is_floating_point() else t)(torch.as_tensor(a))

    def _A_setup():
        B, S, D = (1, 2048, 640)
        return {'x': _w((lambda *s: torch.randn(*s, dtype=torch.bfloat16) * 0.05)(B, S, D)), 'wqkv': _w((lambda *s: torch.randn(*s, dtype=torch.bfloat16) * 0.05)(D, 3 * D)), 'wo': _w((lambda *s: torch.randn(*s, dtype=torch.bfloat16) * 0.05)(D, D))}
    _A_in = _A_setup()

    def _B_setup():
        B, S, Dm, Df = (1, 2048, 640, 1536)
        return {'x': _w((lambda *s: torch.randn(*s, dtype=torch.bfloat16) * 0.05)(B, S, Dm)), 'w_gate': _w((lambda *s: torch.randn(*s, dtype=torch.bfloat16) * 0.8)(Dm, Df) * Dm ** (-0.5)), 'w_up': _w((lambda *s: torch.randn(*s, dtype=torch.bfloat16) * 0.8)(Dm, Df) * Dm ** (-0.5)), 'w_down': _w((lambda *s: torch.randn(*s, dtype=torch.bfloat16) * 0.8)(Df, Dm) * Df ** (-0.5))}
    _B_in = _B_setup()
    return {'A_x': _A_in['x'], 'A_wqkv': _A_in['wqkv'], 'A_wo': _A_in['wo'], 'B_x': _B_in['x'], 'B_w_gate': _B_in['w_gate'], 'B_w_up': _B_in['w_up'], 'B_w_down': _B_in['w_down'], 'c': _w((lambda *s: torch.randn(*s, dtype=torch.bfloat16) * 0.2)(1, 640) * 8.0), 'w_mod': _w((lambda *s: torch.randn(*s, dtype=torch.bfloat16) * 0.2)(640, 6 * 640) * 640 ** (-0.5) * 8.0)}

def reference(A_x, A_wqkv, A_wo, B_x, B_w_gate, B_w_up, B_w_down, c, w_mod):

    def _A_ref(x, wqkv, wo):
        B, S, D = x.shape
        H = 32
        Dh = D // H
        W = 256
        qkv = (lambda x, *d: x.permute(*d))((x @ wqkv).reshape(B, S, 3, H, Dh), 2, 0, 3, 1, 4)
        q, k, v = (qkv[0], qkv[1], qkv[2])
        scores = torch.einsum('bhqd,bhkd->bhqk', q, k) * Dh ** (-0.5)
        idx = torch.arange(S)
        mask = (idx[:, None] - idx[None, :] >= 0) & (idx[:, None] - idx[None, :] < W)
        scores = torch.where(mask[None, None], scores, -1000000000.0)
        p = _softmax(scores, axis=-1)
        o = torch.einsum('bhqk,bhkd->bhqd', p, v)
        return (lambda x, *d: x.permute(*d))(o, 0, 2, 1, 3).reshape(B, S, D) @ wo

    def _B_ref(x, w_gate, w_up, w_down):
        g = torch.einsum('bsd,df->bsf', x, w_gate)
        u = torch.einsum('bsd,df->bsf', x, w_up)
        h = _gelu(g) * u
        return torch.einsum('bsf,fd->bsd', h, w_down)
    x = A_x
    mod = (_silu(c) @ w_mod).reshape(c.shape[0], 6, 1, -1)
    sa, ca, ga, sb, cb, gb = (mod[:, 0].clone(), mod[:, 1].clone(), mod[:, 2].clone(), mod[:, 3].clone(), mod[:, 4].clone(), mod[:, 5].clone())
    h = _layernorm(x, axis=-1) * (1 + ca) + sa
    x = x + ga * _A_ref(h, A_wqkv, A_wo)
    h = _layernorm(x, axis=-1) * (1 + cb) + sb
    x = x + gb * _B_ref(h, B_w_gate, B_w_up, B_w_down)
    return x
```

```asm
; @launch grid=(256,1,1) block=(256,1,1) lds=163840
.amdgcn_target "amdgcn-amd-amdhsa--gfx950"
.text
.globl adaLN_cond__sliding_block__glu_gated_geglu__prompt_kernel
.p2align 8
.type adaLN_cond__sliding_block__glu_gated_geglu__prompt_kernel,@function
adaLN_cond__sliding_block__glu_gated_geglu__prompt_kernel:
    s_cmp_ge_u32 s2, 256
    s_cbranch_scc1 L_main_end
    s_load_dwordx16 s[80:95], s[0:1], 0
    s_load_dwordx8 s[56:63], s[0:1], 64
    s_memrealtime s[76:77]
    s_getpc_b64 s[24:25]
L_pc:
    s_lshr_b32 s26, s2, 3
    s_lshl_b32 s26, s26, 6
    v_lshrrev_b32 v248, 2, v0
    v_add_u32 v248, s26, v248
    v_and_b32 v248, 511, v248
    v_lshlrev_b32 v248, 7, v248
    v_min_u32 v248, L_main_end-L_pc, v248
    global_load_dword v247, v248, s[24:25]
    v_lshrrev_b32 v1, 6, v0
    v_and_b32 v254, 63, v0
    v_readfirstlane_b32 s16, v1
    v_lshlrev_b32 v255, 4, v254
    s_and_b32 s24, s2, 7
    s_lshr_b32 s24, s24, 1
    s_lshl_b32 s24, s24, 2
    s_lshr_b32 s25, s2, 6
    s_add_u32 s17, s24, s25
    s_and_b32 s24, s2, 1
    s_lshl_b32 s24, s24, 3
    s_bfe_u32 s25, s2, 0x30003
    s_add_u32 s18, s24, s25
    s_lshr_b32 s19, s18, 3
    s_and_b32 s20, s18, 7
    s_lshl_b32 s24, s17, 2
    s_add_u32 s21, s24, s16
    s_lshl_b32 s25, s19, 1
    s_add_u32 s22, s24, s25
    s_mov_b32 s65, 0
    v_lshrrev_b32 v1, 4, v254
    v_and_b32 v2, 15, v254
    v_lshlrev_b32 v2, 4, v2
    v_lshl_add_u32 v253, v1, 9, v2
    v_and_b32 v3, 3, v0
    v_bfe_u32 v4, v0, 2, 2
    v_bfe_u32 v5, v0, 4, 2
    s_mul_i32 s66, s2, 137
    s_lshr_b32 s66, s66, 13
    s_mul_i32 s24, s66, 60
    s_sub_u32 s67, s2, s24
    s_cmp_lt_u32 s2, 240
    s_cselect_b32 s69, 0, 0x40000000
    s_lshl_b32 s24, s17, 4
    s_add_u32 s68, s24, s18
    v_and_b32 v7, 7, v0
    v_lshrrev_b32 v2, 3, v0
    v_mul_u32_u24 v13, 7680, v2
    v_lshl_add_u32 v13, v7, 4, v13
    v_lshlrev_b32 v14, 1, v2
    s_mul_i32 s27, s66, 1228800
    s_lshl_b32 s24, s67, 7
    s_add_u32 s27, s27, s24
    s_add_u32 s27, s27, s69
    s_mul_i32 s28, s66, 320
    v_bfe_u32 v6, v0, 3, 3
    v_mul_u32_u24 v15, 1280, v7
    v_lshl_add_u32 v15, v6, 4, v15
    v_cmp_gt_u32 vcc, 4, v6
    v_mov_b32 v36, 2147483647
    s_nop 0
    v_cndmask_b32 v37, v36, v15, vcc
    s_mul_i32 s29, s68, 10240
    s_mul_i32 s24, s16, 320
    s_add_u32 s29, s29, s24
    s_mul_i32 s70, s2, 171
    s_lshr_b32 s70, s70, 10
    s_mul_i32 s24, s70, 6
    s_sub_u32 s24, s2, s24
    s_and_b32 s72, s24, 1
    s_lshr_b32 s71, s24, 1
    s_mul_i32 s23, s70, 61440
    s_mul_i32 s24, s24, 640
    s_add_u32 s23, s23, s24
    s_add_u32 s23, s23, s69
    v_add_u32 v160, 0, v0
    v_mul_u32_u24 v161, 205, v160
    v_lshrrev_b32 v161, 13, v161
    v_mul_u32_u24 v162, 40, v161
    v_sub_u32 v162, v160, v162
    v_mul_u32_u24 v96, 656, v161
    v_lshl_add_u32 v96, v162, 4, v96
    v_mul_u32_u24 v161, 3840, v161
    v_lshl_add_u32 v164, v162, 4, v161
    v_add_u32 v160, 256, v0
    v_mul_u32_u24 v161, 205, v160
    v_lshrrev_b32 v161, 13, v161
    v_mul_u32_u24 v162, 40, v161
    v_sub_u32 v162, v160, v162
    v_mul_u32_u24 v97, 656, v161
    v_lshl_add_u32 v97, v162, 4, v97
    v_mul_u32_u24 v161, 3840, v161
    v_lshl_add_u32 v165, v162, 4, v161
    v_add_u32 v160, 512, v0
    v_mul_u32_u24 v161, 205, v160
    v_lshrrev_b32 v161, 13, v161
    v_mul_u32_u24 v162, 40, v161
    v_sub_u32 v162, v160, v162
    v_mul_u32_u24 v98, 656, v161
    v_lshl_add_u32 v98, v162, 4, v98
    v_mul_u32_u24 v161, 3840, v161
    v_lshl_add_u32 v166, v162, 4, v161
    v_cmp_le_u32 vcc, 128, v0
    s_nop 1
    v_cndmask_b32 v166, v166, v36, vcc
    s_waitcnt lgkmcnt(0)
    s_mov_b32 s52, s60
    s_mov_b32 s53, s61
    s_mov_b32 s54, 256
    s_mov_b32 s55, 0x20000
    s_or_b32 s76, s76, 1
    s_or_b32 s24, s2, s16
    s_cmp_eq_u32 s24, 0
    s_cbranch_scc0 L_notag
    v_mov_b32 v252, s76
    s_mov_b64 exec, 0xff
    buffer_store_dwordx4 v[252:255], v255, s[52:55], s24 offen sc1
    s_mov_b64 exec, -1
L_notag:
    s_mov_b32 s32, s56
    s_mov_b32 s33, s57
    s_mov_b32 s34, 4915200
    s_mov_b32 s35, 0x20000
    s_mov_b32 s36, s94
    s_mov_b32 s37, s95
    s_mov_b32 s38, 1280
    s_mov_b32 s39, 0x20000
    s_mov_b32 s8, s80
    s_mov_b32 s9, s81
    s_mov_b32 s10, 2621440
    s_mov_b32 s11, 0x20000
    s_mov_b32 s40, s82
    s_mov_b32 s41, s83
    s_mov_b32 s42, 2457600
    s_mov_b32 s43, 0x20000
    buffer_load_dwordx4 v[84:87], v164, s[40:43], s23 offen nt
    buffer_load_dwordx4 v[88:91], v165, s[40:43], s23 offen nt
    buffer_load_dwordx4 v[92:95], v166, s[40:43], s23 offen nt
    buffer_load_ushort v8, v14, s[36:39], s28 offen offset:0
    buffer_load_ushort v9, v14, s[36:39], s28 offen offset:64
    buffer_load_ushort v10, v14, s[36:39], s28 offen offset:128
    buffer_load_ushort v11, v14, s[36:39], s28 offen offset:192
    buffer_load_ushort v12, v14, s[36:39], s28 offen offset:256
    buffer_load_dwordx4 v[16:19], v13, s[32:35], s27 offen nt
    s_add_u32 s27, s27, 245760
    buffer_load_dwordx4 v[20:23], v13, s[32:35], s27 offen nt
    s_add_u32 s27, s27, 245760
    buffer_load_dwordx4 v[24:27], v13, s[32:35], s27 offen nt
    s_add_u32 s27, s27, 245760
    buffer_load_dwordx4 v[28:31], v13, s[32:35], s27 offen nt
    s_add_u32 s27, s27, 245760
    buffer_load_dwordx4 v[32:35], v13, s[32:35], s27 offen nt
    s_mov_b32 s4, s62
    s_mov_b32 s5, s63
    s_mov_b32 s6, 31162368
    s_mov_b32 s7, 0x20000
    s_lshl_b32 s24, s2, 2
    s_add_u32 s24, s24, s16
    s_lshl_b32 s24, s24, 7
    s_add_u32 s24, s24, 30965760
    s_lshl_b32 s25, s68, 2
    s_add_u32 s25, s25, s16
    s_lshl_b32 s25, s25, 7
    s_add_u32 s25, s25, 30834688
    v_mov_b32 v40, s24
    v_mov_b32 v41, s25
    v_cmp_eq_u32 vcc, 1, v6
    s_nop 1
    v_cndmask_b32 v40, v40, v41, vcc
    s_lshl_b32 s24, s2, 7
    s_add_u32 s24, s24, 31031296
    v_lshlrev_b32 v41, 15, v6
    v_add_u32 v41, s24, v41
    v_cmp_le_u32 vcc, 2, v6
    s_nop 1
    v_cndmask_b32 v40, v40, v41, vcc
    s_mul_i32 s24, s66, 15360
    s_lshl_b32 s25, s67, 8
    s_add_u32 s24, s24, s25
    s_add_u32 s24, s24, s69
    v_subrev_u32 v41, 4, v6
    v_lshl_add_u32 v41, v41, 7, s24
    v_cmp_le_u32 vcc, 4, v6
    s_nop 1
    v_cndmask_b32 v40, v40, v41, vcc
    v_lshl_add_u32 v40, v7, 4, v40
    v_mov_b32 v60, 0
    v_mov_b32 v61, 0
    v_mov_b32 v62, 0
    v_mov_b32 v63, 0
    s_cmp_eq_u32 s16, 0
    s_cselect_b32 exec_hi, 0xffff, 0
    s_cselect_b32 exec_lo, -1, 0xffff
    buffer_store_dwordx4 v[60:63], v40, s[4:7], 0 offen sc1
    s_mov_b64 exec, -1
    v_mov_b32 v47, v37
    s_mov_b32 s63, s29
    s_mov_b32 s12, s58
    s_mov_b32 s13, s59
    s_mov_b32 s14, 2621440
    s_mov_b32 s15, 0x20000
    v_lshrrev_b32 v14, 1, v5
    v_lshl_add_u32 v160, v14, 3, v4
    v_mul_u32_u24 v160, 656, v160
    s_mul_i32 s24, s16, 160
    s_add_u32 s24, s24, 51200
    v_add_u32 v160, s24, v160
    v_and_b32 v161, 1, v5
    v_mul_u32_u24 v161, 40, v161
    v_lshlrev_b32 v162, 1, v3
    v_and_b32 v162, 2, v162
    v_lshrrev_b32 v163, 1, v3
    v_or_b32 v162, v162, v163
    s_cmp_eq_u32 s71, 2
    s_cselect_b64 vcc, -1, 0
    v_cndmask_b32 v162, v3, v162, vcc
    v_lshl_add_u32 v161, v162, 3, v161
    v_add_u32 v153, v160, v161
    v_mul_u32_u24 v162, 40, v3
    v_add3_u32 v154, v160, v162, 32
    v_bfe_u32 v155, v0, 3, 1
    v_mul_u32_u24 v155, 163840, v155
    v_lshl_add_u32 v155, v7, 4, v155
    v_lshl_add_u32 v155, v14, 9, v155
    s_lshl_b32 s23, s72, 3
    s_lshl_b32 s24, s16, 1
    s_add_u32 s23, s23, s24
    s_mul_i32 s23, s23, 163840
    s_add_u32 s23, s23, 3670016
    s_add_u32 s23, s23, s69
    s_lshl_b32 s24, s70, 11
    s_add_u32 s24, s23, s24
    s_lshl_b32 s25, s70, 10
    s_add_u32 s25, s23, s25
    s_add_u32 s25, s25, 81920
    s_add_u32 s26, s25, 40960
    s_cmp_eq_u32 s71, 1
    s_cselect_b32 s25, s24, s25
    s_cmp_eq_u32 s71, 0
    s_cselect_b32 s78, s26, s25
    s_cselect_b32 s26, 3, s71
    s_sub_u32 s26, s26, 1
    s_lshl_b32 s26, s26, 7
    s_add_u32 s79, s24, s26
    s_mov_b64 s[70:71], s[78:79]
    s_cmp_lt_u32 s2, 192
    s_cbranch_scc0 L_bdec_wd
    s_and_b32 s75, s2, 1
    s_lshr_b32 s24, s2, 1
    s_mul_i32 s73, s24, 43
    s_lshr_b32 s73, s73, 10
    s_mul_i32 s25, s73, 24
    s_sub_u32 s74, s24, s25
    s_cmp_eq_u32 s75, 0
    s_cselect_b32 s44, s88, s90
    s_cselect_b32 s45, s89, s91
    s_mul_i32 s94, s73, 491520
    s_lshl_b32 s24, s74, 7
    s_add_u32 s94, s94, s24
    v_add_u32 v160, 0, v2
    v_mul_u32_u24 v161, 3072, v160
    v_lshl_add_u32 v168, v7, 4, v161
    v_mul_u32_u24 v161, 144, v160
    v_lshl_add_u32 v161, v7, 4, v161
    v_add_u32 v120, 131072, v161
    v_add_u32 v160, 32, v2
    v_mul_u32_u24 v161, 3072, v160
    v_lshl_add_u32 v169, v7, 4, v161
    v_mul_u32_u24 v161, 144, v160
    v_lshl_add_u32 v161, v7, 4, v161
    v_add_u32 v121, 131072, v161
    v_add_u32 v160, 64, v2
    v_mul_u32_u24 v161, 3072, v160
    v_lshl_add_u32 v170, v7, 4, v161
    v_mul_u32_u24 v161, 144, v160
    v_lshl_add_u32 v161, v7, 4, v161
    v_add_u32 v122, 131072, v161
    v_add_u32 v160, 96, v2
    v_mul_u32_u24 v161, 3072, v160
    v_lshl_add_u32 v171, v7, 4, v161
    v_mul_u32_u24 v161, 144, v160
    v_lshl_add_u32 v161, v7, 4, v161
    v_add_u32 v123, 131072, v161
    v_add_u32 v160, 128, v2
    v_mul_u32_u24 v161, 3072, v160
    v_lshl_add_u32 v172, v7, 4, v161
    v_mul_u32_u24 v161, 144, v160
    v_lshl_add_u32 v161, v7, 4, v161
    v_add_u32 v124, 131072, v161
    s_mov_b32 s46, 1966080
    s_branch L_bdec_done
L_bdec_wd:
    s_cmp_lt_u32 s2, 232
    s_cselect_b32 s3, 1, 0
    s_cselect_b32 s44, s84, s92
    s_cselect_b32 s45, s85, s93
    s_mov_b32 s24, 1966080
    s_cselect_b32 s46, 819200, s24
    s_movk_i32 s24, 232
    s_cselect_b32 s24, 192, s24
    s_sub_u32 s23, s2, s24
    s_lshr_b32 s24, s23, 1
    s_and_b32 s75, s23, 1
    s_mul_i32 s25, s24, 43
    s_lshr_b32 s25, s25, 9
    s_mul_i32 s26, s24, 52
    s_lshr_b32 s26, s26, 8
    s_cmp_eq_u32 s3, 1
    s_cselect_b32 s73, s26, s25
    s_cselect_b32 s25, 5, 12
    s_mul_i32 s25, s73, s25
    s_sub_u32 s74, s24, s25
    s_lshr_b32 s24, s23, 1
    s_lshl_b32 s24, s24, 5
    s_and_b32 s25, s74, 1
    s_mul_i32 s25, s25, 80
    s_lshr_b32 s26, s74, 1
    s_mul_i32 s26, s26, 20
    s_add_u32 s25, s25, s26
    s_cmp_eq_u32 s74, 4
    s_cselect_b32 s25, 16, s25
    s_cselect_b64 s[78:79], -1, 0
    s_mul_i32 s26, s73, 160
    s_add_u32 s25, s25, s26
    s_cmp_eq_u32 s3, 1
    s_cselect_b32 s24, s25, s24
    s_cselect_b64 vcc, -1, 0
    s_mul_i32 s94, s24, 1280
    s_mul_i32 s24, s75, 640
    s_add_u32 s94, s94, s24
    v_add_u32 v160, 0, v0
    v_mul_u32_u24 v161, 1639, v160
    v_lshrrev_b32 v161, 16, v161
    v_mul_u32_u24 v162, 40, v161
    v_sub_u32 v162, v160, v162
    v_mul_u32_u24 v163, 656, v161
    v_lshl_add_u32 v163, v162, 4, v163
    v_add_u32 v120, 131072, v163
    v_lshrrev_b32 v40, 4, v161
    v_and_b32 v41, 15, v161
    v_mad_u32_u24 v41, v40, 40, v41
    v_lshlrev_b32 v40, 2, v40
    v_bfe_u32 v42, v161, 2, 1
    v_lshl_add_u32 v40, v42, 1, v40
    v_bfe_u32 v42, v161, 3, 1
    v_add_u32 v40, v40, v42
    v_and_b32 v42, 3, v161
    v_mad_u32_u24 v40, v40, 20, v42
    v_cndmask_b32 v41, v41, v40, s[78:79]
    v_cndmask_b32 v161, v161, v41, vcc
    v_mul_u32_u24 v161, 1280, v161
    v_lshl_add_u32 v168, v162, 4, v161
    v_add_u32 v160, 256, v0
    v_mul_u32_u24 v161, 1639, v160
    v_lshrrev_b32 v161, 16, v161
    v_mul_u32_u24 v162, 40, v161
    v_sub_u32 v162, v160, v162
    v_mul_u32_u24 v163, 656, v161
    v_lshl_add_u32 v163, v162, 4, v163
    v_add_u32 v121, 131072, v163
    v_lshrrev_b32 v40, 4, v161
    v_and_b32 v41, 15, v161
    v_mad_u32_u24 v41, v40, 40, v41
    v_lshlrev_b32 v40, 2, v40
    v_bfe_u32 v42, v161, 2, 1
    v_lshl_add_u32 v40, v42, 1, v40
    v_bfe_u32 v42, v161, 3, 1
    v_add_u32 v40, v40, v42
    v_and_b32 v42, 3, v161
    v_mad_u32_u24 v40, v40, 20, v42
    v_cndmask_b32 v41, v41, v40, s[78:79]
    v_cndmask_b32 v161, v161, v41, vcc
    v_mul_u32_u24 v161, 1280, v161
    v_lshl_add_u32 v169, v162, 4, v161
    v_add_u32 v160, 512, v0
    v_mul_u32_u24 v161, 1639, v160
    v_lshrrev_b32 v161, 16, v161
    v_mul_u32_u24 v162, 40, v161
    v_sub_u32 v162, v160, v162
    v_mul_u32_u24 v163, 656, v161
    v_lshl_add_u32 v163, v162, 4, v163
    v_add_u32 v122, 131072, v163
    v_lshrrev_b32 v40, 4, v161
    v_and_b32 v41, 15, v161
    v_mad_u32_u24 v41, v40, 40, v41
    v_lshlrev_b32 v40, 2, v40
    v_bfe_u32 v42, v161, 2, 1
    v_lshl_add_u32 v40, v42, 1, v40
    v_bfe_u32 v42, v161, 3, 1
    v_add_u32 v40, v40, v42
    v_and_b32 v42, 3, v161
    v_mad_u32_u24 v40, v40, 20, v42
    v_cndmask_b32 v41, v41, v40, s[78:79]
    v_cndmask_b32 v161, v161, v41, vcc
    v_mul_u32_u24 v161, 1280, v161
    v_lshl_add_u32 v170, v162, 4, v161
    v_add_u32 v160, 768, v0
    v_mul_u32_u24 v161, 1639, v160
    v_lshrrev_b32 v161, 16, v161
    v_mul_u32_u24 v162, 40, v161
    v_sub_u32 v162, v160, v162
    v_mul_u32_u24 v163, 656, v161
    v_lshl_add_u32 v163, v162, 4, v163
    v_add_u32 v123, 131072, v163
    v_lshrrev_b32 v40, 4, v161
    v_and_b32 v41, 15, v161
    v_mad_u32_u24 v41, v40, 40, v41
    v_lshlrev_b32 v40, 2, v40
    v_bfe_u32 v42, v161, 2, 1
    v_lshl_add_u32 v40, v42, 1, v40
    v_bfe_u32 v42, v161, 3, 1
    v_add_u32 v40, v40, v42
    v_and_b32 v42, 3, v161
    v_mad_u32_u24 v40, v40, 20, v42
    v_cndmask_b32 v41, v41, v40, s[78:79]
    v_cndmask_b32 v161, v161, v41, vcc
    v_mul_u32_u24 v161, 1280, v161
    v_lshl_add_u32 v171, v162, 4, v161
    v_add_u32 v160, 1024, v0
    v_mul_u32_u24 v161, 1639, v160
    v_lshrrev_b32 v161, 16, v161
    v_mul_u32_u24 v162, 40, v161
    v_sub_u32 v162, v160, v162
    v_mul_u32_u24 v163, 656, v161
    v_lshl_add_u32 v163, v162, 4, v163
    v_add_u32 v124, 131072, v163
    v_lshrrev_b32 v40, 4, v161
    v_and_b32 v41, 15, v161
    v_mad_u32_u24 v41, v40, 40, v41
    v_lshlrev_b32 v40, 2, v40
    v_bfe_u32 v42, v161, 2, 1
    v_lshl_add_u32 v40, v42, 1, v40
    v_bfe_u32 v42, v161, 3, 1
    v_add_u32 v40, v40, v42
    v_and_b32 v42, 3, v161
    v_mad_u32_u24 v40, v40, 20, v42
    v_cndmask_b32 v41, v41, v40, s[78:79]
    v_cndmask_b32 v161, v161, v41, vcc
    v_mul_u32_u24 v161, 1280, v161
    v_lshl_add_u32 v172, v162, 4, v161
L_bdec_done:
    s_mov_b32 s47, 0x20000
    s_mul_i32 s24, s16, 640
    s_lshr_b32 s25, s16, 1
    s_mul_i32 s25, s25, 320
    s_mul_i32 s26, s73, 640
    s_add_u32 s25, s25, s26
    s_add_u32 s25, s25, 7040
    v_mov_b32 v125, s24
    v_mov_b32 v126, s25
    v_cmp_gt_u32 vcc, 40, v254
    s_nop 1
    v_cndmask_b32 v125, v126, v125, vcc
    v_min_u32 v126, 944, v255
    v_add_u32 v125, v125, v126
    s_lshl_b32 s24, s16, 11
    s_add_u32 s24, s24, 122880
    v_add_u32 v127, s24, v255
    v_lshl_add_u32 v126, v14, 5, s24
    v_lshl_add_u32 v128, v6, 5, s24
    v_mov_b32 v200, v126
    s_mul_i32 s28, s16, 6
    s_add_u32 s28, s28, s19
    s_lshl_b32 s28, s28, 2
    s_lshr_b32 s24, s20, 1
    s_add_u32 s28, s28, s24
    s_lshl_b32 s28, s28, 7
    s_add_u32 s56, s28, 30965760
    v_and_b32 v129, 15, v254
    v_lshlrev_b32 v130, 7, v129
    v_min_u32 v129, 9, v129
    v_mul_u32_u24 v129, 12, v129
    v_min_u32 v131, 2, v5
    v_add_lshl_u32 v129, v129, v131, 10
    s_lshl_b32 s57, s21, 11
    s_add_u32 s57, s57, 30834688
    s_lshl_b32 s58, s68, 2
    s_add_u32 s58, s58, s16
    s_lshl_b32 s58, s58, 7
    s_add_u32 s58, s58, 30834688
    s_lshr_b32 s59, s68, 2
    s_mul_i32 s59, s59, 40960
    s_mul_i32 s26, s16, 10240
    s_add_u32 s59, s59, s26
    s_and_b32 s26, s68, 3
    s_lshl_b32 s26, s26, 7
    s_add_u32 s59, s59, s26
    s_add_u32 s59, s59, 1048576
    v_lshlrev_b32 v132, 9, v6
    v_cmp_gt_u32 vcc, 4, v6
    v_lshl_add_u32 v132, v7, 4, v132
    v_mov_b32 v133, 2147483647
    v_cndmask_b32 v133, v133, v132, vcc
    s_waitcnt vmcnt(13)
    ds_write_b128 v96, v[84:87] offset:51200
    s_waitcnt vmcnt(12)
    ds_write_b128 v97, v[88:91] offset:51200
    s_waitcnt vmcnt(11)
    ds_write_b128 v98, v[92:95] offset:51200
    s_waitcnt lgkmcnt(0)
    s_barrier
    ds_read_b64_tr_b16 v[84:85], v153 offset:0
    ds_read_b64_tr_b16 v[86:87], v153 offset:2624
    ds_read_b64_tr_b16 v[88:89], v153 offset:80
    ds_read_b64_tr_b16 v[90:91], v153 offset:2704
    ds_read_b64_tr_b16 v[92:93], v154 offset:0
    ds_read_b64_tr_b16 v[94:95], v154 offset:2624
    s_waitcnt lgkmcnt(4)
    buffer_store_dwordx4 v[84:87], v255, s[4:7], s70 offen sc1
    s_add_u32 s70, s70, 163840
    s_waitcnt lgkmcnt(2)
    buffer_store_dwordx4 v[88:91], v255, s[4:7], s70 offen sc1
    s_waitcnt lgkmcnt(0)
    buffer_store_dwordx4 v[92:95], v155, s[4:7], s71 offen offset:1024 sc1
    buffer_load_dwordx4 v[48:51], v15, s[8:11], s63 offen
    buffer_load_dwordx4 v[52:55], v15, s[8:11], s63 offen offset:128
    buffer_load_dwordx4 v[56:59], v47, s[8:11], s63 offen offset:256
    s_load_dword s64, s[60:61], 0
    s_waitcnt vmcnt(16)
    v_lshlrev_b32 v8, 16, v8
    v_mul_f32 v13, 0xbfb8aa3b, v8
    v_exp_f32 v13, v13
    s_nop 0
    v_add_f32 v13, 1.0, v13
    v_rcp_f32 v13, v13
    s_nop 0
    v_mul_f32 v8, v8, v13
    v_cvt_pk_bf16_f32 v8, v8, v8
    v_lshlrev_b32 v8, 16, v8
    s_waitcnt vmcnt(15)
    v_lshlrev_b32 v9, 16, v9
    v_mul_f32 v13, 0xbfb8aa3b, v9
    v_exp_f32 v13, v13
    s_nop 0
    v_add_f32 v13, 1.0, v13
    v_rcp_f32 v13, v13
    s_nop 0
    v_mul_f32 v9, v9, v13
    v_cvt_pk_bf16_f32 v9, v9, v9
    v_lshlrev_b32 v9, 16, v9
    s_waitcnt vmcnt(14)
    v_lshlrev_b32 v10, 16, v10
    v_mul_f32 v13, 0xbfb8aa3b, v10
    v_exp_f32 v13, v13
    s_nop 0
    v_add_f32 v13, 1.0, v13
    v_rcp_f32 v13, v13
    s_nop 0
    v_mul_f32 v10, v10, v13
    v_cvt_pk_bf16_f32 v10, v10, v10
    v_lshlrev_b32 v10, 16, v10
    s_waitcnt vmcnt(13)
    v_lshlrev_b32 v11, 16, v11
    v_mul_f32 v13, 0xbfb8aa3b, v11
    v_exp_f32 v13, v13
    s_nop 0
    v_add_f32 v13, 1.0, v13
    v_rcp_f32 v13, v13
    s_nop 0
    v_mul_f32 v11, v11, v13
    v_cvt_pk_bf16_f32 v11, v11, v11
    v_lshlrev_b32 v11, 16, v11
    s_waitcnt vmcnt(12)
    v_lshlrev_b32 v12, 16, v12
    v_mul_f32 v13, 0xbfb8aa3b, v12
    v_exp_f32 v13, v13
    s_nop 0
    v_add_f32 v13, 1.0, v13
    v_rcp_f32 v13, v13
    s_nop 0
    v_mul_f32 v12, v12, v13
    v_cvt_pk_bf16_f32 v12, v12, v12
    v_lshlrev_b32 v12, 16, v12
    s_waitcnt vmcnt(11)
    v_lshlrev_b32 v36, 16, v16
    v_and_b32 v37, 0xffff0000, v16
    v_pk_mul_f32 v[40:41], v[36:37], v[8:9] op_sel_hi:[1,0]
    v_lshlrev_b32 v36, 16, v17
    v_and_b32 v37, 0xffff0000, v17
    v_pk_mul_f32 v[42:43], v[36:37], v[8:9] op_sel_hi:[1,0]
    v_lshlrev_b32 v36, 16, v18
    v_and_b32 v37, 0xffff0000, v18
    v_pk_mul_f32 v[44:45], v[36:37], v[8:9] op_sel_hi:[1,0]
    v_lshlrev_b32 v36, 16, v19
    v_and_b32 v37, 0xffff0000, v19
    v_pk_mul_f32 v[46:47], v[36:37], v[8:9] op_sel_hi:[1,0]
    s_waitcnt vmcnt(10)
    v_lshlrev_b32 v36, 16, v20
    v_and_b32 v37, 0xffff0000, v20
    v_pk_fma_f32 v[40:41], v[36:37], v[8:9], v[40:41] op_sel:[0,1,0] op_sel_hi:[1,1,1]
    v_lshlrev_b32 v36, 16, v21
    v_and_b32 v37, 0xffff0000, v21
    v_pk_fma_f32 v[42:43], v[36:37], v[8:9], v[42:43] op_sel:[0,1,0] op_sel_hi:[1,1,1]
    v_lshlrev_b32 v36, 16, v22
    v_and_b32 v37, 0xffff0000, v22
    v_pk_fma_f32 v[44:45], v[36:37], v[8:9], v[44:45] op_sel:[0,1,0] op_sel_hi:[1,1,1]
    v_lshlrev_b32 v36, 16, v23
    v_and_b32 v37, 0xffff0000, v23
    v_pk_fma_f32 v[46:47], v[36:37], v[8:9], v[46:47] op_sel:[0,1,0] op_sel_hi:[1,1,1]
    s_waitcnt vmcnt(9)
    v_lshlrev_b32 v36, 16, v24
    v_and_b32 v37, 0xffff0000, v24
    v_pk_fma_f32 v[40:41], v[36:37], v[10:11], v[40:41] op_sel_hi:[1,0,1]
    v_lshlrev_b32 v36, 16, v25
    v_and_b32 v37, 0xffff0000, v25
    v_pk_fma_f32 v[42:43], v[36:37], v[10:11], v[42:43] op_sel_hi:[1,0,1]
    v_lshlrev_b32 v36, 16, v26
    v_and_b32 v37, 0xffff0000, v26
    v_pk_fma_f32 v[44:45], v[36:37], v[10:11], v[44:45] op_sel_hi:[1,0,1]
    v_lshlrev_b32 v36, 16, v27
    v_and_b32 v37, 0xffff0000, v27
    v_pk_fma_f32 v[46:47], v[36:37], v[10:11], v[46:47] op_sel_hi:[1,0,1]
    s_waitcnt vmcnt(8)
    v_lshlrev_b32 v36, 16, v28
    v_and_b32 v37, 0xffff0000, v28
    v_pk_fma_f32 v[40:41], v[36:37], v[10:11], v[40:41] op_sel:[0,1,0] op_sel_hi:[1,1,1]
    v_lshlrev_b32 v36, 16, v29
    v_and_b32 v37, 0xffff0000, v29
    v_pk_fma_f32 v[42:43], v[36:37], v[10:11], v[42:43] op_sel:[0,1,0] op_sel_hi:[1,1,1]
    v_lshlrev_b32 v36, 16, v30
    v_and_b32 v37, 0xffff0000, v30
    v_pk_fma_f32 v[44:45], v[36:37], v[10:11], v[44:45] op_sel:[0,1,0] op_sel_hi:[1,1,1]
    v_lshlrev_b32 v36, 16, v31
    v_and_b32 v37, 0xffff0000, v31
    v_pk_fma_f32 v[46:47], v[36:37], v[10:11], v[46:47] op_sel:[0,1,0] op_sel_hi:[1,1,1]
    s_waitcnt vmcnt(7)
    v_lshlrev_b32 v36, 16, v32
    v_and_b32 v37, 0xffff0000, v32
    v_pk_fma_f32 v[40:41], v[36:37], v[12:13], v[40:41] op_sel_hi:[1,0,1]
    v_lshlrev_b32 v36, 16, v33
    v_and_b32 v37, 0xffff0000, v33
    v_pk_fma_f32 v[42:43], v[36:37], v[12:13], v[42:43] op_sel_hi:[1,0,1]
    v_lshlrev_b32 v36, 16, v34
    v_and_b32 v37, 0xffff0000, v34
    v_pk_fma_f32 v[44:45], v[36:37], v[12:13], v[44:45] op_sel_hi:[1,0,1]
    v_lshlrev_b32 v36, 16, v35
    v_and_b32 v37, 0xffff0000, v35
    v_pk_fma_f32 v[46:47], v[36:37], v[12:13], v[46:47] op_sel_hi:[1,0,1]
    v_permlane32_swap_b32 v40, v44
    v_permlane32_swap_b32 v41, v45
    v_permlane32_swap_b32 v42, v46
    v_permlane32_swap_b32 v43, v47
    v_pk_add_f32 v[40:41], v[40:41], v[44:45]
    v_pk_add_f32 v[42:43], v[42:43], v[46:47]
    s_nop 1
    v_permlane16_swap_b32 v40, v42
    v_permlane16_swap_b32 v41, v43
    v_pk_add_f32 v[40:41], v[40:41], v[42:43]
    s_nop 1
    v_add_f32_dpp v42, v40, v40 row_ror:8 row_mask:0xf bank_mask:0xf
    v_add_f32_dpp v43, v41, v41 row_ror:8 row_mask:0xf bank_mask:0xf
    s_lshl_b32 s24, s16, 8
    v_lshl_add_u32 v13, v7, 5, s24
    v_lshl_add_u32 v13, v5, 3, v13
    ds_write_b64 v13, v[42:43] offset:49152
    v_min_u32 v13, 240, v255
    s_mul_i32 s24, s66, 15360
    s_lshl_b32 s25, s67, 8
    s_add_u32 s24, s24, s25
    s_add_u32 s24, s24, s69
    s_cmp_eq_u32 s16, 0
    s_cselect_b32 s76, 0, 0x20000000
    s_add_u32 s24, s24, s76
    s_waitcnt lgkmcnt(0)
    s_barrier
    ds_read_b128 v[16:19], v13 offset:49152
    ds_read_b128 v[20:23], v13 offset:49408
    ds_read_b128 v[24:27], v13 offset:49664
    ds_read_b128 v[28:31], v13 offset:49920
L_tag:
    s_cmp_lg_u32 s64, 0
    s_cbranch_scc1 L_tag_ok
    buffer_load_dword v39, off, s[52:55], 0 sc1
    s_waitcnt vmcnt(0)
    v_readfirstlane_b32 s64, v39
    s_add_u32 s65, s65, 1
    s_cmp_lt_u32 s65, 0x40000
    s_cbranch_scc1 L_tag
L_tag_ok:
    v_mov_b32 v252, s64
    s_waitcnt lgkmcnt(2)
    v_pk_add_f32 v[16:17], v[16:17], v[20:21]
    s_waitcnt lgkmcnt(0)
    v_pk_add_f32 v[24:25], v[24:25], v[28:29]
    v_pk_add_f32 v[16:17], v[16:17], v[24:25]
    v_pk_add_f32 v[18:19], v[18:19], v[22:23]
    v_pk_add_f32 v[26:27], v[26:27], v[30:31]
    v_pk_add_f32 v[18:19], v[18:19], v[26:27]
    s_mov_b32 s25, 0x07060503
    v_perm_b32 v16, v16, v19, s25
    s_mov_b32 s25, 0x07060502
    v_perm_b32 v17, v17, v19, s25
    s_mov_b32 s25, 0x07060501
    v_perm_b32 v18, v18, v19, s25
    v_mov_b32 v19, s64
    s_waitcnt vmcnt(6)
    s_mov_b64 exec, 0xffff
    buffer_store_dwordx4 v[16:19], v13, s[4:7], s24 offen offset:0 sc1
    s_mov_b64 exec, -1
    s_lshl_b32 s72, s2, 2
    s_add_u32 s72, s72, s16
    s_lshl_b32 s72, s72, 7
    s_add_u32 s72, s72, 30965760
    s_waitcnt vmcnt(4)
    s_mov_b64 exec, 255
    buffer_store_dwordx4 v[252:255], v255, s[4:7], s72 offen sc1
    s_mov_b64 exec, -1
    buffer_load_dwordx4 v[100:103], v168, s[44:47], s94 offen nt
    buffer_load_dwordx4 v[104:107], v169, s[44:47], s94 offen nt
    buffer_load_dwordx4 v[108:111], v170, s[44:47], s94 offen nt
    buffer_load_dwordx4 v[112:115], v171, s[44:47], s94 offen nt
    buffer_load_dwordx4 v[116:119], v172, s[44:47], s94 offen nt
    s_waitcnt vmcnt(9)
    v_lshlrev_b32 v60, 16, v48
    v_and_b32 v61, 0xffff0000, v48
    v_pk_mul_f32 v[10:11], v[60:61], v[60:61]
    v_lshlrev_b32 v62, 16, v49
    v_and_b32 v63, 0xffff0000, v49
    v_pk_add_f32 v[8:9], v[62:63], v[60:61]
    v_pk_fma_f32 v[10:11], v[62:63], v[62:63], v[10:11]
    v_lshlrev_b32 v64, 16, v50
    v_and_b32 v65, 0xffff0000, v50
    v_pk_add_f32 v[8:9], v[64:65], v[8:9]
    v_pk_fma_f32 v[10:11], v[64:65], v[64:65], v[10:11]
    v_lshlrev_b32 v66, 16, v51
    v_and_b32 v67, 0xffff0000, v51
    v_pk_add_f32 v[8:9], v[66:67], v[8:9]
    v_pk_fma_f32 v[10:11], v[66:67], v[66:67], v[10:11]
    s_waitcnt vmcnt(8)
    v_lshlrev_b32 v68, 16, v52
    v_and_b32 v69, 0xffff0000, v52
    v_pk_add_f32 v[8:9], v[68:69], v[8:9]
    v_pk_fma_f32 v[10:11], v[68:69], v[68:69], v[10:11]
    v_lshlrev_b32 v70, 16, v53
    v_and_b32 v71, 0xffff0000, v53
    v_pk_add_f32 v[8:9], v[70:71], v[8:9]
    v_pk_fma_f32 v[10:11], v[70:71], v[70:71], v[10:11]
    v_lshlrev_b32 v72, 16, v54
    v_and_b32 v73, 0xffff0000, v54
    v_pk_add_f32 v[8:9], v[72:73], v[8:9]
    v_pk_fma_f32 v[10:11], v[72:73], v[72:73], v[10:11]
    v_lshlrev_b32 v74, 16, v55
    v_and_b32 v75, 0xffff0000, v55
    v_pk_add_f32 v[8:9], v[74:75], v[8:9]
    v_pk_fma_f32 v[10:11], v[74:75], v[74:75], v[10:11]
    s_waitcnt vmcnt(7)
    v_lshlrev_b32 v76, 16, v56
    v_and_b32 v77, 0xffff0000, v56
    v_pk_add_f32 v[8:9], v[76:77], v[8:9]
    v_pk_fma_f32 v[10:11], v[76:77], v[76:77], v[10:11]
    v_lshlrev_b32 v78, 16, v57
    v_and_b32 v79, 0xffff0000, v57
    v_pk_add_f32 v[8:9], v[78:79], v[8:9]
    v_pk_fma_f32 v[10:11], v[78:79], v[78:79], v[10:11]
    v_lshlrev_b32 v80, 16, v58
    v_and_b32 v81, 0xffff0000, v58
    v_pk_add_f32 v[8:9], v[80:81], v[8:9]
    v_pk_fma_f32 v[10:11], v[80:81], v[80:81], v[10:11]
    v_lshlrev_b32 v82, 16, v59
    v_and_b32 v83, 0xffff0000, v59
    v_pk_add_f32 v[8:9], v[82:83], v[8:9]
    v_pk_fma_f32 v[10:11], v[82:83], v[82:83], v[10:11]
    v_add_f32 v8, v8, v9
    v_add_f32 v9, v10, v11
    s_nop 0
    v_add_f32_dpp v10, v8, v8 row_ror:8 row_mask:0xf bank_mask:0xf
    v_mov_b32 v8, v10
    s_nop 1
    v_permlane16_swap_b32 v8, v10
    v_add_f32 v8, v8, v10
    v_mov_b32 v10, v8
    s_nop 1
    v_permlane32_swap_b32 v8, v10
    v_add_f32 v8, v8, v10
    s_nop 0
    v_add_f32_dpp v10, v9, v9 row_ror:8 row_mask:0xf bank_mask:0xf
    v_mov_b32 v9, v10
    s_nop 1
    v_permlane16_swap_b32 v9, v10
    v_add_f32 v9, v9, v10
    v_mov_b32 v10, v9
    s_nop 1
    v_permlane32_swap_b32 v9, v10
    v_add_f32 v9, v9, v10
    s_lshl_b32 s24, s16, 3
    v_lshl_add_u32 v12, v7, 5, s24
    ds_write_b64 v12, v[8:9] offset:50176
    v_lshlrev_b32 v12, 5, v7
    s_waitcnt lgkmcnt(0)
    s_barrier
    ds_read_b128 v[20:23], v12 offset:50176
    ds_read_b128 v[24:27], v12 offset:50192
    s_waitcnt lgkmcnt(1)
    v_pk_add_f32 v[20:21], v[20:21], v[22:23]
    s_waitcnt lgkmcnt(0)
    v_pk_add_f32 v[24:25], v[24:25], v[26:27]
    v_pk_add_f32 v[20:21], v[20:21], v[24:25]
    v_mul_f32 v28, 0xbacccccd, v20
    v_mov_b32 v30, 0x3727c5ac
    v_mul_f32 v29, 0x3acccccd, v21
    v_fma_f32 v29, -v28, v28, v29
    v_max_f32 v29, 0, v29
    v_add_f32 v30, v30, v29
    v_rsq_f32 v30, v30
    s_nop 0
    v_mul_f32 v32, v28, v30
    s_mov_b32 s25, 0
    buffer_load_dwordx4 v[204:207], v125, s[4:7], s25 offen offset:0 sc1
    buffer_load_dwordx4 v[220:223], v125, s[4:7], s25 offen offset:2560 sc1
    s_add_u32 s25, s25, 15360
    buffer_load_dwordx4 v[208:211], v125, s[4:7], s25 offen offset:0 sc1
    buffer_load_dwordx4 v[224:227], v125, s[4:7], s25 offen offset:2560 sc1
    s_add_u32 s25, s25, 15360
    buffer_load_dwordx4 v[212:215], v125, s[4:7], s25 offen offset:0 sc1
    buffer_load_dwordx4 v[228:231], v125, s[4:7], s25 offen offset:2560 sc1
    s_add_u32 s25, s25, 15360
    buffer_load_dwordx4 v[216:219], v125, s[4:7], s25 offen offset:0 sc1
    buffer_load_dwordx4 v[232:235], v125, s[4:7], s25 offen offset:2560 sc1
    v_pk_fma_f32 v[60:61], v[60:61], v[30:31], v[32:33] op_sel_hi:[1,0,0]
    v_pk_fma_f32 v[62:63], v[62:63], v[30:31], v[32:33] op_sel_hi:[1,0,0]
    v_pk_fma_f32 v[64:65], v[64:65], v[30:31], v[32:33] op_sel_hi:[1,0,0]
    v_pk_fma_f32 v[66:67], v[66:67], v[30:31], v[32:33] op_sel_hi:[1,0,0]
    v_pk_fma_f32 v[68:69], v[68:69], v[30:31], v[32:33] op_sel_hi:[1,0,0]
    v_pk_fma_f32 v[70:71], v[70:71], v[30:31], v[32:33] op_sel_hi:[1,0,0]
    v_pk_fma_f32 v[72:73], v[72:73], v[30:31], v[32:33] op_sel_hi:[1,0,0]
    v_pk_fma_f32 v[74:75], v[74:75], v[30:31], v[32:33] op_sel_hi:[1,0,0]
    v_pk_fma_f32 v[76:77], v[76:77], v[30:31], v[32:33] op_sel_hi:[1,0,0]
    v_pk_fma_f32 v[78:79], v[78:79], v[30:31], v[32:33] op_sel_hi:[1,0,0]
    v_pk_fma_f32 v[80:81], v[80:81], v[30:31], v[32:33] op_sel_hi:[1,0,0]
    v_pk_fma_f32 v[82:83], v[82:83], v[30:31], v[32:33] op_sel_hi:[1,0,0]
    s_mul_i32 s69, s18, 163840
    s_add_u32 s69, s69, 3670016
    v_and_b32 v134, 24, v254
    v_cmp_eq_u32 vcc, 24, v134
    v_mov_b32 v134, 2147483647
    s_nop 0
    v_cndmask_b32 v134, v255, v134, vcc
    buffer_load_dword v244, v129, s[4:7], s56 offen sc1
    s_mov_b32 s48, s92
    s_mov_b32 s49, s93
    s_mov_b32 s50, 1966080
    s_mov_b32 s51, 0x20000
    s_bfe_u32 s25, s2, 0x20003
    s_xor_b32 s25, s25, s16
    s_cmp_ge_u32 s2, 224
    s_cselect_b32 s24, 1, 3
    s_and_b32 s24, s24, s25
    s_cselect_b32 s77, 0x40000000, 0
    s_and_b32 s25, s25, 2
    s_lshl_b32 s25, s25, 4
    s_add_u32 s23, s2, s25
    s_and_b32 s99, s23, 7
    s_lshr_b32 s23, s23, 3
    s_add_u32 s23, s23, 12
    s_mul_i32 s97, s23, 43
    s_lshr_b32 s97, s97, 9
    s_mul_i32 s24, s97, 12
    s_sub_u32 s98, s23, s24
    s_mul_i32 s95, s23, 40960
    s_mul_i32 s24, s99, 160
    s_add_u32 s95, s95, s24
    s_add_u32 s95, s95, s77
    s_mul_i32 s24, s16, 5632
    s_add_u32 s24, s24, 65536
    v_add_u32 v136, 0, v254
    v_mul_u32_u24 v137, 205, v136
    v_lshrrev_b32 v137, 11, v137
    v_mul_u32_u24 v138, 10, v137
    v_sub_u32 v138, v136, v138
    v_mul_u32_u24 v139, 176, v137
    v_lshl_add_u32 v139, v138, 4, v139
    v_add_u32 v139, s24, v139
    v_accvgpr_write_b32 a232, v139
    v_mul_u32_u24 v137, 1280, v137
    v_lshl_add_u32 v144, v138, 4, v137
    v_add_u32 v136, 64, v254
    v_mul_u32_u24 v137, 205, v136
    v_lshrrev_b32 v137, 11, v137
    v_mul_u32_u24 v138, 10, v137
    v_sub_u32 v138, v136, v138
    v_mul_u32_u24 v139, 176, v137
    v_lshl_add_u32 v139, v138, 4, v139
    v_add_u32 v139, s24, v139
    v_accvgpr_write_b32 a233, v139
    v_mul_u32_u24 v137, 1280, v137
    v_lshl_add_u32 v145, v138, 4, v137
    v_add_u32 v136, 128, v254
    v_mul_u32_u24 v137, 205, v136
    v_lshrrev_b32 v137, 11, v137
    v_mul_u32_u24 v138, 10, v137
    v_sub_u32 v138, v136, v138
    v_mul_u32_u24 v139, 176, v137
    v_lshl_add_u32 v139, v138, 4, v139
    v_add_u32 v139, s24, v139
    v_accvgpr_write_b32 a234, v139
    v_mul_u32_u24 v137, 1280, v137
    v_lshl_add_u32 v146, v138, 4, v137
    v_add_u32 v136, 192, v254
    v_mul_u32_u24 v137, 205, v136
    v_lshrrev_b32 v137, 11, v137
    v_mul_u32_u24 v138, 10, v137
    v_sub_u32 v138, v136, v138
    v_mul_u32_u24 v139, 176, v137
    v_lshl_add_u32 v139, v138, 4, v139
    v_add_u32 v139, s24, v139
    v_accvgpr_write_b32 a235, v139
    v_mul_u32_u24 v137, 1280, v137
    v_lshl_add_u32 v147, v138, 4, v137
    v_add_u32 v136, 256, v254
    v_mul_u32_u24 v137, 205, v136
    v_lshrrev_b32 v137, 11, v137
    v_mul_u32_u24 v138, 10, v137
    v_sub_u32 v138, v136, v138
    v_mul_u32_u24 v139, 176, v137
    v_lshl_add_u32 v139, v138, 4, v139
    v_add_u32 v139, s24, v139
    v_accvgpr_write_b32 a236, v139
    v_mul_u32_u24 v137, 1280, v137
    v_lshl_add_u32 v151, v138, 4, v137
    s_mov_b32 s65, 0x8000
    s_waitcnt vmcnt(1)
    v_mov_b32 v38, v235
L_modp:
    v_xor_b32 v207, s64, v207
    v_xor_b32 v211, s64, v211
    v_xor_b32 v215, s64, v215
    v_xor_b32 v219, s64, v219
    v_xor_b32 v223, s64, v223
    v_xor_b32 v227, s64, v227
    v_xor_b32 v231, s64, v231
    v_xor_b32 v235, s64, v235
    v_or3_b32 v38, v207, v211, v215
    v_or3_b32 v38, v38, v219, v223
    v_or3_b32 v38, v38, v227, v231
    v_or_b32 v38, v38, v235
    v_cmp_ne_u32 vcc, 0, v38
    s_cbranch_vccz L_modp_ok
    s_mov_b32 s25, 0
    buffer_load_dwordx4 v[204:207], v125, s[4:7], s25 offen offset:0 sc1
    buffer_load_dwordx4 v[220:223], v125, s[4:7], s25 offen offset:2560 sc1
    s_add_u32 s25, s25, 15360
    buffer_load_dwordx4 v[208:211], v125, s[4:7], s25 offen offset:0 sc1
    buffer_load_dwordx4 v[224:227], v125, s[4:7], s25 offen offset:2560 sc1
    s_add_u32 s25, s25, 15360
    buffer_load_dwordx4 v[212:215], v125, s[4:7], s25 offen offset:0 sc1
    buffer_load_dwordx4 v[228:231], v125, s[4:7], s25 offen offset:2560 sc1
    s_add_u32 s25, s25, 15360
    buffer_load_dwordx4 v[216:219], v125, s[4:7], s25 offen offset:0 sc1
    buffer_load_dwordx4 v[232:235], v125, s[4:7], s25 offen offset:2560 sc1
    s_waitcnt vmcnt(0)
    s_sub_u32 s65, s65, 1
    s_cbranch_scc0 L_modp
L_modp_ok:
    s_mov_b32 s24, 0x04000c0c
    s_mov_b32 s26, 0x0706000c
    v_perm_b32 v207, v204, v205, s24
    v_perm_b32 v207, v207, v206, s26
    v_perm_b32 v211, v208, v209, s24
    v_perm_b32 v211, v211, v210, s26
    v_perm_b32 v215, v212, v213, s24
    v_perm_b32 v215, v215, v214, s26
    v_perm_b32 v219, v216, v217, s24
    v_perm_b32 v219, v219, v218, s26
    v_pk_add_f32 v[204:205], v[204:205], v[208:209]
    v_pk_add_f32 v[212:213], v[212:213], v[216:217]
    v_pk_add_f32 v[204:205], v[204:205], v[212:213]
    v_cvt_pk_bf16_f32 v38, v204, v205
    v_lshlrev_b32 v204, 16, v38
    v_and_b32 v205, 0xffff0000, v38
    v_pk_add_f32 v[206:207], v[206:207], v[210:211]
    v_pk_add_f32 v[214:215], v[214:215], v[218:219]
    v_pk_add_f32 v[206:207], v[206:207], v[214:215]
    v_cvt_pk_bf16_f32 v38, v206, v207
    v_lshlrev_b32 v206, 16, v38
    v_and_b32 v207, 0xffff0000, v38
    ds_write_b128 v127, v[204:207] offset:0
    s_mov_b32 s24, 0x04000c0c
    s_mov_b32 s26, 0x0706000c
    v_perm_b32 v223, v220, v221, s24
    v_perm_b32 v223, v223, v222, s26
    v_perm_b32 v227, v224, v225, s24
    v_perm_b32 v227, v227, v226, s26
    v_perm_b32 v231, v228, v229, s24
    v_perm_b32 v231, v231, v230, s26
    v_perm_b32 v235, v232, v233, s24
    v_perm_b32 v235, v235, v234, s26
    v_pk_add_f32 v[220:221], v[220:221], v[224:225]
    v_pk_add_f32 v[228:229], v[228:229], v[232:233]
    v_pk_add_f32 v[220:221], v[220:221], v[228:229]
    v_cvt_pk_bf16_f32 v38, v220, v221
    v_lshlrev_b32 v220, 16, v38
    v_and_b32 v221, 0xffff0000, v38
    v_pk_add_f32 v[220:221], v[220:221], 1.0 op_sel_hi:[1,0]
    v_cvt_pk_bf16_f32 v38, v220, v221
    v_lshlrev_b32 v220, 16, v38
    v_and_b32 v221, 0xffff0000, v38
    v_pk_add_f32 v[222:223], v[222:223], v[226:227]
    v_pk_add_f32 v[230:231], v[230:231], v[234:235]
    v_pk_add_f32 v[222:223], v[222:223], v[230:231]
    v_cvt_pk_bf16_f32 v38, v222, v223
    v_lshlrev_b32 v222, 16, v38
    v_and_b32 v223, 0xffff0000, v38
    v_pk_add_f32 v[222:223], v[222:223], 1.0 op_sel_hi:[1,0]
    v_cvt_pk_bf16_f32 v38, v222, v223
    v_lshlrev_b32 v222, 16, v38
    v_and_b32 v223, 0xffff0000, v38
    ds_write_b128 v127, v[220:223] offset:1024
    s_waitcnt lgkmcnt(0)
    ds_read_b128 v[204:207], v128 offset:0
    ds_read_b128 v[208:211], v128 offset:16
    ds_read_b128 v[212:215], v128 offset:1024
    ds_read_b128 v[216:219], v128 offset:1040
    ds_read_b128 v[220:223], v128 offset:256
    ds_read_b128 v[224:227], v128 offset:272
    ds_read_b128 v[228:231], v128 offset:1280
    ds_read_b128 v[232:235], v128 offset:1296
    ds_read_b128 v[16:19], v128 offset:512
    ds_read_b128 v[20:23], v128 offset:528
    ds_read_b128 v[24:27], v128 offset:1536
    ds_read_b128 v[28:31], v128 offset:1552
    s_waitcnt lgkmcnt(9)
    v_pk_fma_f32 v[60:61], v[60:61], v[212:213], v[204:205]
    v_cvt_pk_bf16_f32 v48, v60, v61
    v_pk_fma_f32 v[62:63], v[62:63], v[214:215], v[206:207]
    v_cvt_pk_bf16_f32 v49, v62, v63
    s_waitcnt lgkmcnt(8)
    v_pk_fma_f32 v[64:65], v[64:65], v[216:217], v[208:209]
    v_cvt_pk_bf16_f32 v50, v64, v65
    v_pk_fma_f32 v[66:67], v[66:67], v[218:219], v[210:211]
    v_cvt_pk_bf16_f32 v51, v66, v67
    buffer_store_dwordx4 v[48:51], v132, s[4:7], s59 offen sc1
    s_add_u32 s59, s59, 4096
    s_waitcnt lgkmcnt(5)
    v_pk_fma_f32 v[68:69], v[68:69], v[228:229], v[220:221]
    v_cvt_pk_bf16_f32 v52, v68, v69
    v_pk_fma_f32 v[70:71], v[70:71], v[230:231], v[222:223]
    v_cvt_pk_bf16_f32 v53, v70, v71
    s_waitcnt lgkmcnt(4)
    v_pk_fma_f32 v[72:73], v[72:73], v[232:233], v[224:225]
    v_cvt_pk_bf16_f32 v54, v72, v73
    v_pk_fma_f32 v[74:75], v[74:75], v[234:235], v[226:227]
    v_cvt_pk_bf16_f32 v55, v74, v75
    buffer_store_dwordx4 v[52:55], v132, s[4:7], s59 offen sc1
    s_add_u32 s59, s59, 4096
    s_waitcnt lgkmcnt(1)
    v_pk_fma_f32 v[76:77], v[76:77], v[24:25], v[16:17]
    v_cvt_pk_bf16_f32 v56, v76, v77
    v_pk_fma_f32 v[78:79], v[78:79], v[26:27], v[18:19]
    v_cvt_pk_bf16_f32 v57, v78, v79
    s_waitcnt lgkmcnt(0)
    v_pk_fma_f32 v[80:81], v[80:81], v[28:29], v[20:21]
    v_cvt_pk_bf16_f32 v58, v80, v81
    v_pk_fma_f32 v[82:83], v[82:83], v[30:31], v[22:23]
    v_cvt_pk_bf16_f32 v59, v82, v83
    buffer_store_dwordx4 v[56:59], v133, s[4:7], s59 offen sc1
    s_waitcnt vmcnt(3)
    v_cmp_ne_u32 vcc, s64, v244
    s_cbranch_vccz L_pdone_wq
    s_mov_b32 s65, 0x20000
L_poll_wq:
    buffer_load_dword v244, v129, s[4:7], s56 offen sc1
    s_waitcnt vmcnt(0)
    v_cmp_ne_u32 vcc, s64, v244
    s_cbranch_vccz L_pdone_wq
    s_sub_u32 s65, s65, 1
    s_cbranch_scc0 L_poll_wq
L_pdone_wq:
    s_mul_i32 s70, s16, 2048
    s_add_u32 m0, s70, 0
    s_add_u32 s71, s70, s69
    buffer_load_dwordx4 v255, s[4:7], s71 offen offset:0 sc1 lds
    buffer_load_dwordx4 v134, s[4:7], s71 offen offset:1024 sc1 lds
    s_add_u32 m0, s70, 8192
    s_add_u32 s71, s71, 8192
    buffer_load_dwordx4 v255, s[4:7], s71 offen offset:0 sc1 lds
    buffer_load_dwordx4 v134, s[4:7], s71 offen offset:1024 sc1 lds
    s_lshl_b32 s24, s99, 2
    s_add_u32 s24, s24, s97
    s_mul_i32 s24, s24, 12
    s_mul_i32 s25, s98, 86
    s_lshr_b32 s25, s25, 8
    s_mul_i32 s25, s25, 11
    s_lshl_b32 s27, s98, 2
    s_sub_u32 s25, s27, s25
    s_add_u32 s24, s24, s25
    s_mul_i32 s24, s24, 5120
    s_add_u32 s96, s24, 27820032
    s_add_u32 s96, s96, s77
    s_cmp_lt_u32 s2, 192
    s_cbranch_scc0 L_bd_wd
    s_lshr_b32 s27, s16, 1
    s_and_b32 s25, s16, 1
    v_lshl_add_u32 v156, v14, 3, v4
    v_mul_u32_u24 v156, 144, v156
    v_and_b32 v157, 1, v5
    v_lshlrev_b32 v157, 5, v157
    v_lshl_add_u32 v157, v3, 3, v157
    s_mul_i32 s24, s27, 11520
    s_lshl_b32 s26, s25, 6
    s_add_u32 s24, s24, s26
    s_add_u32 s24, s24, 131072
    v_add3_u32 v159, v156, v157, s24
    s_lshl_b32 s28, s74, 1
    s_add_u32 s28, s28, s25
    s_mul_i32 s24, s28, 86
    s_lshr_b32 s24, s24, 8
    s_mul_i32 s25, s24, 3
    s_sub_u32 s25, s28, s25
    s_lshl_b32 s26, s73, 1
    s_add_u32 s27, s27, s26
    s_mul_i32 s26, s27, 10240
    s_mul_i32 s24, s24, 245760
    s_add_u32 s24, s24, 17596416
    s_lshl_b32 s29, s75, 10
    s_add_u32 s24, s24, s29
    s_mul_i32 s29, s25, 81920
    s_movk_i32 s98, 2048
    s_add_u32 s24, s24, s29
    s_add_u32 s97, s24, s26
    s_mul_i32 s24, s27, 48
    s_add_u32 s24, s24, s28
    s_lshl_b32 s24, s24, 1
    s_add_u32 s24, s24, s75
    s_lshl_b32 s24, s24, 8
    s_add_u32 s99, s24, 262144
    s_branch L_bd_done
L_bd_wd:
    s_lshl_b32 s24, s75, 2
    s_add_u32 s24, s24, s16
    s_lshl_b32 s24, s24, 2
    s_add_u32 s24, s24, s73
    s_cmp_eq_u32 s3, 1
    s_cselect_b32 s25, 5, 12
    s_mov_b32 s26, 27820032
    s_cselect_b32 s26, 14155776, s26
    s_mul_i32 s24, s24, s25
    s_mul_i32 s25, s74, 86
    s_lshr_b32 s25, s25, 8
    s_mul_i32 s25, s25, 11
    s_lshl_b32 s27, s74, 2
    s_sub_u32 s25, s27, s25
    s_cmp_eq_u32 s3, 1
    s_cselect_b32 s25, s74, s25
    s_add_u32 s24, s24, s25
    s_mul_i32 s24, s24, 5120
    s_add_u32 s97, s24, s26
    s_movk_i32 s98, 1024
    s_mov_b32 s99, 0x40000000
L_bd_done:
    s_lshl_b32 s24, s21, 4
    s_add_u32 s24, s24, s18
    s_mul_i32 s83, s24, 5120
    s_add_u32 s83, s83, 6291456
    s_lshl_b32 s24, s24, 7
    s_add_u32 s84, s24, 29786112
    s_add_u32 s85, s24, 29917184
    v_and_b32 v158, 31, v254
    v_lshlrev_b32 v158, 5, v158
    v_lshrrev_b32 v201, 5, v254
    v_lshl_add_u32 v158, v201, 4, v158
    s_add_u32 s24, s16, 8
    s_mul_i32 s24, s24, 5136
    v_add_u32 v154, s24, v255
    v_add_u32 v155, s24, v158
    v_min_u32 v150, 11, v254
    v_mul_u32_u24 v150, 5136, v150
    v_mov_b32 v152, 0x3f803f80
    v_mov_b32 v153, 0x3f803f80
    s_mov_b32 s90, 0x3ea52b5c
    s_mov_b32 s91, s90
    s_lshl_b32 s24, s17, 2
    s_lshl_b32 s25, s16, 1
    s_add_u32 s24, s24, s25
    s_mul_i32 s88, s25, 5136
    s_max_u32 s25, s24, 8
    s_sub_u32 s25, s25, 8
    s_lshl_b32 s25, s25, 4
    s_add_u32 s25, s25, s18
    s_mul_i32 s87, s25, 5120
    s_add_u32 s87, s87, 6291456
    s_lshl_b32 s25, s25, 7
    s_add_u32 s25, s25, 29786112
    s_cmp_ge_u32 s24, 8
    s_cselect_b32 s86, s25, s84
    s_cselect_b64 s[30:31], -1, 0
    v_mov_b32 v201, 0x7fffffff
    v_cndmask_b32 v156, v201, v255, s[30:31]
    v_and_b32 v201, 1, v254
    v_lshlrev_b32 v201, 11, v201
    v_cndmask_b32 v157, 0, v201, s[30:31]
    s_lshl_b32 s24, s2, 7
    s_cmp_eq_u32 s16, 0
    s_cselect_b32 s25, 0, 0x40000000
    s_add_u32 s24, s24, s25
    s_add_u32 s92, s24, 31096832
    s_waitcnt vmcnt(4)
    s_mov_b64 exec, 255
    buffer_store_dwordx4 v[252:255], v255, s[4:7], s58 offen sc1
    s_mov_b64 exec, -1
    s_mov_b32 s3, s95
    s_add_u32 m0, s70, 16384
    s_add_u32 s71, s71, 8192
    buffer_load_dwordx4 v255, s[4:7], s71 offen offset:0 sc1 lds
    buffer_load_dwordx4 v134, s[4:7], s71 offen offset:1024 sc1 lds
    s_add_u32 m0, s70, 24576
    s_add_u32 s71, s71, 8192
    buffer_load_dwordx4 v255, s[4:7], s71 offen offset:0 sc1 lds
    buffer_load_dwordx4 v134, s[4:7], s71 offen offset:1024 sc1 lds
    s_add_u32 m0, s70, 32768
    s_add_u32 s71, s71, 8192
    buffer_load_dwordx4 v255, s[4:7], s71 offen offset:0 sc1 lds
    buffer_load_dwordx4 v134, s[4:7], s71 offen offset:1024 sc1 lds
    s_add_u32 m0, s70, 40960
    s_add_u32 s71, s71, 8192
    buffer_load_dwordx4 v255, s[4:7], s71 offen offset:0 sc1 lds
    buffer_load_dwordx4 v134, s[4:7], s71 offen offset:1024 sc1 lds
    s_barrier
    s_add_u32 m0, s70, 49152
    s_add_u32 s71, s71, 8192
    buffer_load_dwordx4 v255, s[4:7], s71 offen offset:0 sc1 lds
    buffer_load_dwordx4 v134, s[4:7], s71 offen offset:1024 sc1 lds
    s_add_u32 m0, s70, 57344
    s_add_u32 s71, s71, 8192
    buffer_load_dwordx4 v255, s[4:7], s71 offen offset:0 sc1 lds
    buffer_load_dwordx4 v134, s[4:7], s71 offen offset:1024 sc1 lds
    s_add_u32 m0, s70, 65536
    s_add_u32 s71, s71, 8192
    buffer_load_dwordx4 v255, s[4:7], s71 offen offset:0 sc1 lds
    buffer_load_dwordx4 v134, s[4:7], s71 offen offset:1024 sc1 lds
    s_add_u32 m0, s70, 73728
    s_add_u32 s71, s71, 8192
    buffer_load_dwordx4 v255, s[4:7], s71 offen offset:0 sc1 lds
    buffer_load_dwordx4 v134, s[4:7], s71 offen offset:1024 sc1 lds
    s_mul_i32 s70, s16, 2048
    s_add_u32 m0, s70, 81920
    s_add_u32 s71, s70, s69
    s_add_u32 s71, s71, 81920
    buffer_load_dwordx4 v255, s[4:7], s71 offen offset:0 sc1 lds
    buffer_load_dwordx4 v255, s[4:7], s71 offen offset:1024 sc1 lds
    s_add_u32 m0, s70, 90112
    s_add_u32 s71, s71, 8192
    buffer_load_dwordx4 v255, s[4:7], s71 offen offset:0 sc1 lds
    buffer_load_dwordx4 v255, s[4:7], s71 offen offset:1024 sc1 lds
    s_add_u32 m0, s70, 98304
    s_add_u32 s71, s71, 8192
    buffer_load_dwordx4 v255, s[4:7], s71 offen offset:0 sc1 lds
    buffer_load_dwordx4 v255, s[4:7], s71 offen offset:1024 sc1 lds
    buffer_load_dword v244, v130, s[4:7], s57 offen sc1
    s_add_u32 m0, s70, 106496
    s_add_u32 s71, s71, 8192
    buffer_load_dwordx4 v255, s[4:7], s71 offen offset:0 sc1 lds
    buffer_load_dwordx4 v255, s[4:7], s71 offen offset:1024 sc1 lds
    s_add_u32 m0, s70, 114688
    s_add_u32 s71, s71, 8192
    buffer_load_dwordx4 v255, s[4:7], s71 offen offset:0 sc1 lds
    buffer_load_dwordx4 v255, s[4:7], s71 offen offset:1024 sc1 lds
    s_waitcnt vmcnt(4)
    v_cmp_ne_u32 vcc, s64, v244
    s_cbranch_vccz L_pdone_h1
    s_mov_b32 s65, 0x20000
L_poll_h1:
    buffer_load_dword v244, v130, s[4:7], s57 offen sc1
    s_waitcnt vmcnt(0)
    v_cmp_ne_u32 vcc, s64, v244
    s_cbranch_vccz L_pdone_h1
    s_sub_u32 s65, s65, 1
    s_cbranch_scc0 L_poll_h1
L_pdone_h1:
    s_mul_i32 s68, s21, 40960
    s_add_u32 s68, s68, 1048576
    buffer_load_dwordx4 a[0:3], v255, s[4:7], s68 offen offset:0 sc1
    buffer_load_dwordx4 a[4:7], v255, s[4:7], s68 offen offset:1024 sc1
    buffer_load_dwordx4 a[8:11], v255, s[4:7], s68 offen offset:2048 sc1
    buffer_load_dwordx4 a[12:15], v255, s[4:7], s68 offen offset:3072 sc1
    s_add_u32 s68, s68, 4096
    buffer_load_dwordx4 a[16:19], v255, s[4:7], s68 offen offset:0 sc1
    buffer_load_dwordx4 a[20:23], v255, s[4:7], s68 offen offset:1024 sc1
    buffer_load_dwordx4 a[24:27], v255, s[4:7], s68 offen offset:2048 sc1
    buffer_load_dwordx4 a[28:31], v255, s[4:7], s68 offen offset:3072 sc1
    s_add_u32 s68, s68, 4096
    buffer_load_dwordx4 a[32:35], v255, s[4:7], s68 offen offset:0 sc1
    buffer_load_dwordx4 a[36:39], v255, s[4:7], s68 offen offset:1024 sc1
    buffer_load_dwordx4 a[40:43], v255, s[4:7], s68 offen offset:2048 sc1
    buffer_load_dwordx4 a[44:47], v255, s[4:7], s68 offen offset:3072 sc1
    ds_write_b128 v120, v[100:103]
    ds_write_b128 v121, v[104:107]
    ds_write_b128 v122, v[108:111]
    ds_write_b128 v123, v[112:115]
    ds_write_b128 v124, v[116:119]
    s_waitcnt lgkmcnt(0)
    s_barrier
    s_cmp_lt_u32 s2, 192
    s_cbranch_scc0 L_btr_wd
    ds_read_b64_tr_b16 v[160:161], v159 offset:0
    ds_read_b64_tr_b16 v[162:163], v159 offset:576
    ds_read_b64_tr_b16 v[164:165], v159 offset:2304
    ds_read_b64_tr_b16 v[166:167], v159 offset:2880
    ds_read_b64_tr_b16 v[168:169], v159 offset:4608
    ds_read_b64_tr_b16 v[170:171], v159 offset:5184
    ds_read_b64_tr_b16 v[172:173], v159 offset:6912
    ds_read_b64_tr_b16 v[174:175], v159 offset:7488
    ds_read_b64_tr_b16 v[176:177], v159 offset:9216
    ds_read_b64_tr_b16 v[178:179], v159 offset:9792
    s_branch L_btr_done
L_btr_wd:
    v_lshrrev_b32 v40, 1, v5
    v_lshl_add_u32 v40, v40, 4, v4
    v_and_b32 v41, 1, v5
    v_lshl_add_u32 v40, v41, 2, v40
    v_mul_u32_u24 v40, 656, v40
    s_mul_i32 s24, s16, 160
    s_add_u32 s24, s24, 131072
    v_add_u32 v40, s24, v40
    v_lshl_add_u32 v41, v3, 4, v40
    v_lshl_add_u32 v42, v3, 3, v40
    ds_read_b64_tr_b16 v[160:161], v41 offset:0
    ds_read_b64_tr_b16 v[162:163], v41 offset:5248
    ds_read_b64_tr_b16 v[164:165], v41 offset:8
    ds_read_b64_tr_b16 v[166:167], v41 offset:5256
    ds_read_b64_tr_b16 v[168:169], v41 offset:64
    ds_read_b64_tr_b16 v[170:171], v41 offset:5312
    ds_read_b64_tr_b16 v[172:173], v41 offset:72
    ds_read_b64_tr_b16 v[174:175], v41 offset:5320
    ds_read_b64_tr_b16 v[176:177], v42 offset:128
    ds_read_b64_tr_b16 v[178:179], v42 offset:5376
L_btr_done:
    s_waitcnt lgkmcnt(0)
    s_waitcnt vmcnt(12)
    s_barrier
    v_add_u32 v148, 65536, v255
    v_add_u32 v149, 131072, v255
    ds_read_b128 v[64:67], v255 offset:0
    ds_read_b128 v[68:71], v255 offset:1024
    ds_read_b128 v[72:75], v255 offset:2048
    ds_read_b128 v[76:79], v255 offset:3072
    ds_read_b128 v[80:83], v255 offset:4096
    ds_read_b128 v[84:87], v255 offset:5120
    s_waitcnt vmcnt(11) lgkmcnt(4)
    v_mfma_f32_32x32x16_bf16 v[0:15], v[64:67], a[0:3], 0
    ds_read_b128 v[88:91], v255 offset:6144
    s_add_u32 s68, s68, 4096
    buffer_load_dwordx4 a[48:51], v255, s[4:7], s68 offen offset:0 sc1
    ds_read_b128 v[96:99], v200 offset:640
    ds_read_b128 v[100:103], v200 offset:656
    ds_read_b128 v[104:107], v200 offset:1664
    ds_read_b128 v[108:111], v200 offset:1680
    v_mfma_f32_32x32x16_bf16 v[16:31], v[68:71], a[0:3], 0
    ds_read_b128 v[92:95], v255 offset:7168
    buffer_store_dwordx4 v[160:163], v255, s[4:7], s97 offen sc1
    v_mov_b32 v140, 0
    v_mov_b32 v141, 0
    ds_read_b128 v[112:115], v200 offset:704
    ds_read_b128 v[116:119], v200 offset:720
    s_waitcnt vmcnt(12) lgkmcnt(10)
    v_mfma_f32_32x32x16_bf16 v[0:15], v[72:75], a[4:7], v[0:15]
    ds_read_b128 v[64:67], v255 offset:8192
    buffer_load_dwordx4 a[52:55], v255, s[4:7], s68 offen offset:1024 sc1
    ds_read_b128 v[120:123], v200 offset:1728
    ds_read_b128 v[124:127], v200 offset:1744
    v_lshlrev_b32 v142, 16, v160
    v_and_b32 v143, 0xffff0000, v160
    v_mfma_f32_32x32x16_bf16 v[16:31], v[76:79], a[4:7], v[16:31]
    ds_read_b128 v[68:71], v255 offset:9216
    s_waitcnt lgkmcnt(9)
    v_fmac_f32 v141, v142, v96
    s_waitcnt lgkmcnt(7)
    v_fmac_f32 v140, v142, v104
    v_fmac_f32 v141, v143, v97
    v_fmac_f32 v140, v143, v105
    s_waitcnt vmcnt(12)
    v_mfma_f32_32x32x16_bf16 v[0:15], v[80:83], a[8:11], v[0:15]
    ds_read_b128 v[72:75], v255 offset:10240
    buffer_load_dwordx4 a[56:59], v255, s[4:7], s68 offen offset:2048 sc1
    v_lshlrev_b32 v142, 16, v161
    v_and_b32 v143, 0xffff0000, v161
    v_fmac_f32 v141, v142, v98
    v_fmac_f32 v140, v142, v106
    v_mfma_f32_32x32x16_bf16 v[16:31], v[84:87], a[8:11], v[16:31]
    ds_read_b128 v[76:79], v255 offset:11264
    v_fmac_f32 v141, v143, v99
    v_fmac_f32 v140, v143, v107
    v_lshlrev_b32 v142, 16, v162
    v_and_b32 v143, 0xffff0000, v162
    s_waitcnt vmcnt(12)
    v_mfma_f32_32x32x16_bf16 v[0:15], v[88:91], a[12:15], v[0:15]
    ds_read_b128 v[80:83], v255 offset:12288
    buffer_load_dwordx4 a[60:63], v255, s[4:7], s68 offen offset:3072 sc1
    v_fmac_f32 v141, v142, v100
    v_fmac_f32 v140, v142, v108
    v_fmac_f32 v141, v143, v101
    v_fmac_f32 v140, v143, v109
    s_waitcnt lgkmcnt(8)
    v_mfma_f32_32x32x16_bf16 v[16:31], v[92:95], a[12:15], v[16:31]
    ds_read_b128 v[84:87], v255 offset:13312
    v_lshlrev_b32 v142, 16, v163
    v_and_b32 v143, 0xffff0000, v163
    v_fmac_f32 v141, v142, v102
    v_fmac_f32 v140, v142, v110
    s_waitcnt vmcnt(12) lgkmcnt(6)
    v_mfma_f32_32x32x16_bf16 v[0:15], v[64:67], a[16:19], v[0:15]
    ds_read_b128 v[88:91], v255 offset:14336
    s_add_u32 s68, s68, 4096
    buffer_load_dwordx4 a[64:67], v255, s[4:7], s68 offen offset:0 sc1
    v_fmac_f32 v141, v143, v103
    v_fmac_f32 v140, v143, v111
    ds_read_b128 v[96:99], v200 offset:768
    ds_read_b128 v[100:103], v200 offset:784
    s_waitcnt lgkmcnt(6)
    v_mfma_f32_32x32x16_bf16 v[16:31], v[68:71], a[16:19], v[16:31]
    ds_read_b128 v[92:95], v255 offset:15360
    s_add_u32 s97, s97, s98
    buffer_store_dwordx4 v[164:167], v255, s[4:7], s97 offen sc1
    ds_read_b128 v[104:107], v200 offset:1792
    ds_read_b128 v[108:111], v200 offset:1808
    v_lshlrev_b32 v142, 16, v164
    v_and_b32 v143, 0xffff0000, v164
    s_waitcnt vmcnt(13)
    v_mfma_f32_32x32x16_bf16 v[0:15], v[72:75], a[20:23], v[0:15]
    ds_read_b128 v[64:67], v255 offset:16384
    buffer_load_dwordx4 a[68:71], v255, s[4:7], s68 offen offset:1024 sc1
    v_fmac_f32 v141, v142, v112
    v_fmac_f32 v140, v142, v120
    v_fmac_f32 v141, v143, v113
    v_fmac_f32 v140, v143, v121
    s_waitcnt lgkmcnt(8)
    v_mfma_f32_32x32x16_bf16 v[16:31], v[76:79], a[20:23], v[16:31]
    ds_read_b128 v[68:71], v255 offset:17408
    v_lshlrev_b32 v142, 16, v165
    v_and_b32 v143, 0xffff0000, v165
    v_fmac_f32 v141, v142, v114
    v_fmac_f32 v140, v142, v122
    s_waitcnt vmcnt(13)
    v_mfma_f32_32x32x16_bf16 v[0:15], v[80:83], a[24:27], v[0:15]
    ds_read_b128 v[72:75], v255 offset:18432
    buffer_load_dwordx4 a[72:75], v255, s[4:7], s68 offen offset:2048 sc1
    v_fmac_f32 v141, v143, v115
    v_fmac_f32 v140, v143, v123
    v_lshlrev_b32 v142, 16, v166
    v_and_b32 v143, 0xffff0000, v166
    s_waitcnt lgkmcnt(8)
    v_mfma_f32_32x32x16_bf16 v[16:31], v[84:87], a[24:27], v[16:31]
    ds_read_b128 v[76:79], v255 offset:19456
    v_fmac_f32 v141, v142, v116
    v_fmac_f32 v140, v142, v124
    v_fmac_f32 v141, v143, v117
    v_fmac_f32 v140, v143, v125
    s_waitcnt vmcnt(13)
    v_mfma_f32_32x32x16_bf16 v[0:15], v[88:91], a[28:31], v[0:15]
    ds_read_b128 v[80:83], v255 offset:20480
    buffer_load_dwordx4 a[76:79], v255, s[4:7], s68 offen offset:3072 sc1
    v_lshlrev_b32 v142, 16, v167
    v_and_b32 v143, 0xffff0000, v167
    v_fmac_f32 v141, v142, v118
    v_fmac_f32 v140, v142, v126
    s_waitcnt lgkmcnt(6)
    v_mfma_f32_32x32x16_bf16 v[16:31], v[92:95], a[28:31], v[16:31]
    ds_read_b128 v[84:87], v255 offset:21504
    v_fmac_f32 v141, v143, v119
    v_fmac_f32 v140, v143, v127
    ds_read_b128 v[112:115], v200 offset:832
    ds_read_b128 v[116:119], v200 offset:848
    s_waitcnt vmcnt(13) lgkmcnt(6)
    v_mfma_f32_32x32x16_bf16 v[0:15], v[64:67], a[32:35], v[0:15]
    ds_read_b128 v[88:91], v255 offset:22528
    s_add_u32 s68, s68, 4096
    buffer_load_dwordx4 a[80:83], v255, s[4:7], s68 offen offset:0 sc1
    ds_read_b128 v[120:123], v200 offset:1856
    ds_read_b128 v[124:127], v200 offset:1872
    v_lshlrev_b32 v142, 16, v168
    v_and_b32 v143, 0xffff0000, v168
    v_mfma_f32_32x32x16_bf16 v[16:31], v[68:71], a[32:35], v[16:31]
    ds_read_b128 v[92:95], v255 offset:23552
    s_add_u32 s97, s97, s98
    buffer_store_dwordx4 v[168:171], v255, s[4:7], s97 offen sc1
    v_fmac_f32 v141, v142, v96
    v_fmac_f32 v140, v142, v104
    v_fmac_f32 v141, v143, v97
    v_fmac_f32 v140, v143, v105
    s_waitcnt vmcnt(14) lgkmcnt(8)
    v_mfma_f32_32x32x16_bf16 v[0:15], v[72:75], a[36:39], v[0:15]
    ds_read_b128 v[64:67], v255 offset:24576
    buffer_load_dwordx4 a[84:87], v255, s[4:7], s68 offen offset:1024 sc1
    v_lshlrev_b32 v142, 16, v169
    v_and_b32 v143, 0xffff0000, v169
    v_fmac_f32 v141, v142, v98
    v_fmac_f32 v140, v142, v106
    v_mfma_f32_32x32x16_bf16 v[16:31], v[76:79], a[36:39], v[16:31]
    ds_read_b128 v[68:71], v255 offset:25600
    v_fmac_f32 v141, v143, v99
    v_fmac_f32 v140, v143, v107
    v_lshlrev_b32 v142, 16, v170
    v_and_b32 v143, 0xffff0000, v170
    s_waitcnt vmcnt(14) lgkmcnt(8)
    v_mfma_f32_32x32x16_bf16 v[0:15], v[80:83], a[40:43], v[0:15]
    ds_read_b128 v[72:75], v255 offset:26624
    buffer_load_dwordx4 a[88:91], v255, s[4:7], s68 offen offset:2048 sc1
    v_fmac_f32 v141, v142, v100
    v_fmac_f32 v140, v142, v108
    v_fmac_f32 v141, v143, v101
    v_fmac_f32 v140, v143, v109
    v_mfma_f32_32x32x16_bf16 v[16:31], v[84:87], a[40:43], v[16:31]
    ds_read_b128 v[76:79], v255 offset:27648
    v_lshlrev_b32 v142, 16, v171
    v_and_b32 v143, 0xffff0000, v171
    v_fmac_f32 v141, v142, v102
    v_fmac_f32 v140, v142, v110
    s_waitcnt vmcnt(14) lgkmcnt(6)
    v_mfma_f32_32x32x16_bf16 v[0:15], v[88:91], a[44:47], v[0:15]
    ds_read_b128 v[80:83], v255 offset:28672
    buffer_load_dwordx4 a[92:95], v255, s[4:7], s68 offen offset:3072 sc1
    v_fmac_f32 v141, v143, v103
    v_fmac_f32 v140, v143, v111
    ds_read_b128 v[96:99], v200 offset:896
    ds_read_b128 v[100:103], v200 offset:912
    s_waitcnt lgkmcnt(6)
    v_mfma_f32_32x32x16_bf16 v[16:31], v[92:95], a[44:47], v[16:31]
    ds_read_b128 v[84:87], v255 offset:29696
    ds_read_b128 v[104:107], v200 offset:1920
    ds_read_b128 v[108:111], v200 offset:1936
    v_lshlrev_b32 v142, 16, v172
    v_and_b32 v143, 0xffff0000, v172
    s_waitcnt vmcnt(14)
    v_mfma_f32_32x32x16_bf16 v[0:15], v[64:67], a[48:51], v[0:15]
    ds_read_b128 v[88:91], v255 offset:30720
    s_add_u32 s68, s68, 4096
    buffer_load_dwordx4 a[96:99], v255, s[4:7], s68 offen offset:0 sc1
    v_fmac_f32 v141, v142, v112
    v_fmac_f32 v140, v142, v120
    v_fmac_f32 v141, v143, v113
    v_fmac_f32 v140, v143, v121
    s_waitcnt lgkmcnt(8)
    v_mfma_f32_32x32x16_bf16 v[16:31], v[68:71], a[48:51], v[16:31]
    ds_read_b128 v[92:95], v255 offset:31744
    s_add_u32 s97, s97, s98
    buffer_store_dwordx4 v[172:175], v255, s[4:7], s97 offen sc1
    v_lshlrev_b32 v142, 16, v173
    v_and_b32 v143, 0xffff0000, v173
    v_fmac_f32 v141, v142, v114
    v_fmac_f32 v140, v142, v122
    s_waitcnt vmcnt(14)
    v_mfma_f32_32x32x16_bf16 v[0:15], v[72:75], a[52:55], v[0:15]
    ds_read_b128 v[64:67], v255 offset:32768
    buffer_load_dwordx4 a[100:103], v255, s[4:7], s68 offen offset:1024 sc1
    v_fmac_f32 v141, v143, v115
    v_fmac_f32 v140, v143, v123
    v_lshlrev_b32 v142, 16, v174
    v_and_b32 v143, 0xffff0000, v174
    s_waitcnt lgkmcnt(8)
    v_mfma_f32_32x32x16_bf16 v[16:31], v[76:79], a[52:55], v[16:31]
    ds_read_b128 v[68:71], v255 offset:33792
    v_fmac_f32 v141, v142, v116
    v_fmac_f32 v140, v142, v124
    v_fmac_f32 v141, v143, v117
    v_fmac_f32 v140, v143, v125
    s_waitcnt vmcnt(14)
    v_mfma_f32_32x32x16_bf16 v[0:15], v[80:83], a[56:59], v[0:15]
    ds_read_b128 v[72:75], v255 offset:34816
    buffer_load_dwordx4 a[104:107], v255, s[4:7], s68 offen offset:2048 sc1
    v_lshlrev_b32 v142, 16, v175
    v_and_b32 v143, 0xffff0000, v175
    v_fmac_f32 v141, v142, v118
    v_fmac_f32 v140, v142, v126
    s_waitcnt lgkmcnt(6)
    v_mfma_f32_32x32x16_bf16 v[16:31], v[84:87], a[56:59], v[16:31]
    ds_read_b128 v[76:79], v255 offset:35840
    v_fmac_f32 v141, v143, v119
    v_fmac_f32 v140, v143, v127
    v_lshlrev_b32 v142, 16, v176
    v_and_b32 v143, 0xffff0000, v176
    s_waitcnt vmcnt(14) lgkmcnt(4)
    v_mfma_f32_32x32x16_bf16 v[0:15], v[88:91], a[60:63], v[0:15]
    ds_read_b128 v[80:83], v255 offset:36864
    buffer_load_dwordx4 a[108:111], v255, s[4:7], s68 offen offset:3072 sc1
    v_fmac_f32 v141, v142, v96
    v_fmac_f32 v140, v142, v104
    v_fmac_f32 v141, v143, v97
    v_fmac_f32 v140, v143, v105
    v_mfma_f32_32x32x16_bf16 v[16:31], v[92:95], a[60:63], v[16:31]
    ds_read_b128 v[84:87], v255 offset:37888
    v_lshlrev_b32 v142, 16, v177
    v_and_b32 v143, 0xffff0000, v177
    v_fmac_f32 v141, v142, v98
    v_fmac_f32 v140, v142, v106
    s_waitcnt vmcnt(14) lgkmcnt(4)
    v_mfma_f32_32x32x16_bf16 v[0:15], v[64:67], a[64:67], v[0:15]
    ds_read_b128 v[88:91], v255 offset:38912
    s_add_u32 s68, s68, 4096
    buffer_load_dwordx4 a[112:115], v255, s[4:7], s68 offen offset:0 sc1
    v_fmac_f32 v141, v143, v99
    v_fmac_f32 v140, v143, v107
    v_lshlrev_b32 v142, 16, v178
    v_and_b32 v143, 0xffff0000, v178
    v_mfma_f32_32x32x16_bf16 v[16:31], v[68:71], a[64:67], v[16:31]
    ds_read_b128 v[92:95], v255 offset:39936
    s_add_u32 s97, s97, s98
    buffer_store_dwordx4 v[176:179], v255, s[4:7], s97 offen sc1
    v_fmac_f32 v141, v142, v100
    v_fmac_f32 v140, v142, v108
    v_fmac_f32 v141, v143, v101
    v_fmac_f32 v140, v143, v109
    s_waitcnt vmcnt(14) lgkmcnt(4)
    v_mfma_f32_32x32x16_bf16 v[0:15], v[72:75], a[68:71], v[0:15]
    ds_read_b128 v[64:67], v255 offset:40960
    buffer_load_dwordx4 a[116:119], v255, s[4:7], s68 offen offset:1024 sc1
    v_lshlrev_b32 v142, 16, v179
    v_and_b32 v143, 0xffff0000, v179
    v_fmac_f32 v141, v142, v102
    v_fmac_f32 v140, v142, v110
    v_mfma_f32_32x32x16_bf16 v[16:31], v[76:79], a[68:71], v[16:31]
    ds_read_b128 v[68:71], v255 offset:41984
    v_fmac_f32 v141, v143, v103
    v_fmac_f32 v140, v143, v111
    v_lshlrev_b32 v142, 3, v254
    s_nop 0
    s_waitcnt vmcnt(14) lgkmcnt(4)
    v_mfma_f32_32x32x16_bf16 v[0:15], v[80:83], a[72:75], v[0:15]
    ds_read_b128 v[72:75], v255 offset:43008
    buffer_load_dwordx4 a[120:123], v255, s[4:7], s68 offen offset:2048 sc1
    v_permlane32_swap_b32 v140, v141
    v_add_f32 v140, v140, v141
    v_mov_b32 v141, v140
    s_nop 1
    v_mfma_f32_32x32x16_bf16 v[16:31], v[84:87], a[72:75], v[16:31]
    ds_read_b128 v[76:79], v255 offset:44032
    v_permlane32_swap_b32 v140, v141
    s_mov_b32 exec_hi, 0
    buffer_store_dwordx2 v[140:141], v142, s[4:7], s99 offen sc1
    s_mov_b32 exec_hi, -1
    s_waitcnt vmcnt(15) lgkmcnt(4)
    v_mfma_f32_32x32x16_bf16 v[0:15], v[88:91], a[76:79], v[0:15]
    ds_read_b128 v[80:83], v255 offset:45056
    buffer_load_dwordx4 a[124:127], v255, s[4:7], s68 offen offset:3072 sc1
    s_lshl_b32 s77, s20, 2
    s_add_u32 s77, s77, s16
    s_mul_i32 s77, s77, 25600
    s_add_u32 s77, s77, 14155776
    v_mfma_f32_32x32x16_bf16 v[16:31], v[92:95], a[76:79], v[16:31]
    ds_read_b128 v[84:87], v255 offset:46080
    s_lshl_b32 s74, s20, 2
    s_add_u32 s74, s74, s16
    s_mul_i32 s74, s74, 61440
    s_add_u32 s74, s74, 27820032
    s_waitcnt vmcnt(15) lgkmcnt(4)
    v_mfma_f32_32x32x16_bf16 v[0:15], v[64:67], a[80:83], v[0:15]
    ds_read_b128 v[88:91], v255 offset:47104
    s_add_u32 s68, s68, 4096
    buffer_load_dwordx4 a[128:131], v255, s[4:7], s68 offen offset:0 sc1
    s_mul_i32 s23, s18, 245760
    s_add_u32 s23, s23, 17596416
    v_and_b32 v201, 3, v254
    v_bfe_u32 v202, v254, 2, 1
    v_mfma_f32_32x32x16_bf16 v[16:31], v[68:71], a[80:83], v[16:31]
    ds_read_b128 v[92:95], v255 offset:48128
    v_bfe_u32 v203, v254, 3, 1
    s_mul_i32 s24, s18, 3
    s_and_b32 s24, s24, 0xfffe
    v_mad_u32_u24 v219, v201, 48, s24
    s_waitcnt vmcnt(14) lgkmcnt(4)
    v_mfma_f32_32x32x16_bf16 v[0:15], v[72:75], a[84:87], v[0:15]
    ds_read_b128 v[64:67], v255 offset:49152
    buffer_load_dwordx4 a[132:135], v255, s[4:7], s68 offen offset:1024 sc1
    v_lshl_add_u32 v219, v202, 1, v219
    v_add_u32 v219, v219, v203
    s_mul_i32 s24, s20, 5
    s_lshr_b32 s24, s24, 2
    v_mfma_f32_32x32x16_bf16 v[16:31], v[76:79], a[84:87], v[16:31]
    ds_read_b128 v[68:71], v255 offset:50176
    s_add_u32 s24, s24, 20
    v_mad_u32_u24 v204, v201, 60, s24
    v_mad_u32_u24 v204, v203, 30, v204
    v_cmp_gt_u32 vcc, 16, v254
    s_waitcnt vmcnt(14) lgkmcnt(4)
    v_mfma_f32_32x32x16_bf16 v[0:15], v[80:83], a[88:91], v[0:15]
    ds_read_b128 v[72:75], v255 offset:51200
    buffer_load_dwordx4 a[136:139], v255, s[4:7], s68 offen offset:2048 sc1
    v_add_u32 v204, v204, v202
    s_lshr_b32 s25, s20, 2
    v_cndmask_b32 v219, v204, v219, vcc
    s_mul_i32 s24, s16, 96
    v_mfma_f32_32x32x16_bf16 v[16:31], v[84:87], a[88:91], v[16:31]
    ds_read_b128 v[76:79], v255 offset:52224
    s_add_u32 s24, s24, s20
    s_sub_u32 s24, s24, 352
    v_lshl_add_u32 v204, v254, 3, s24
    v_cmp_le_i32 vcc, 256, v204
    s_waitcnt vmcnt(14) lgkmcnt(4)
    v_mfma_f32_32x32x16_bf16 v[0:15], v[88:91], a[92:95], v[0:15]
    ds_read_b128 v[80:83], v255 offset:53248
    buffer_load_dwordx4 a[140:143], v255, s[4:7], s68 offen offset:3072 sc1
    v_subrev_u32 v205, 32, v204
    s_nop 0
    v_cndmask_b32 v204, v204, v205, vcc
    s_add_u32 s24, s25, 168
    v_mfma_f32_32x32x16_bf16 v[16:31], v[92:95], a[92:95], v[16:31]
    ds_read_b128 v[84:87], v255 offset:54272
    v_lshl_add_u32 v205, v254, 1, s24
    s_cmp_eq_u32 s16, 0
    s_cselect_b64 vcc, -1, 0
    s_mul_i32 s24, s16, 10
    v_cndmask_b32 v204, v204, v205, vcc
    s_waitcnt vmcnt(14) lgkmcnt(4)
    v_mfma_f32_32x32x16_bf16 v[0:15], v[64:67], a[96:99], v[0:15]
    ds_read_b128 v[88:91], v255 offset:55296
    s_add_u32 s68, s68, 4096
    buffer_load_dwordx4 a[144:147], v255, s[4:7], s68 offen offset:0 sc1
    v_cmp_gt_u32 vcc, 32, v254
    s_add_u32 s24, s24, s25
    s_add_u32 s24, s24, 104
    v_cndmask_b32 v219, v204, v219, vcc
    v_mfma_f32_32x32x16_bf16 v[16:31], v[68:71], a[96:99], v[16:31]
    ds_read_b128 v[92:95], v255 offset:56320
    v_cmp_gt_u32 vcc, 44, v254
    v_min_u32 v204, 48, v254
    v_lshl_add_u32 v204, v204, 1, s24
    v_cndmask_b32 v219, v204, v219, vcc
    s_waitcnt vmcnt(13) lgkmcnt(4)
    v_mfma_f32_32x32x16_bf16 v[0:15], v[72:75], a[100:103], v[0:15]
    ds_read_b128 v[64:67], v255 offset:57344
    buffer_load_dwordx4 a[148:151], v255, s[4:7], s68 offen offset:1024 sc1
    s_mul_i32 s24, s20, 5
    s_lshr_b32 s24, s24, 2
    s_add_u32 s24, s24, 40
    v_cmp_gt_u32 vcc, 56, v254
    v_mfma_f32_32x32x16_bf16 v[16:31], v[76:79], a[100:103], v[16:31]
    ds_read_b128 v[68:71], v255 offset:58368
    v_mad_u32_u24 v204, v201, 60, s24
    v_add_u32 v204, v204, v202
    v_cndmask_b32 v219, v204, v219, vcc
    v_lshlrev_b32 v219, 7, v219
    s_waitcnt vmcnt(13) lgkmcnt(4)
    v_mfma_f32_32x32x16_bf16 v[0:15], v[80:83], a[104:107], v[0:15]
    ds_read_b128 v[72:75], v255 offset:59392
    buffer_load_dwordx4 a[152:155], v255, s[4:7], s68 offen offset:2048 sc1
    s_mov_b32 s89, 31096832
    s_mul_i32 s75, s20, 320
    s_add_u32 s75, s75, 5120
    v_min_u32 v242, 944, v255
    v_mfma_f32_32x32x16_bf16 v[16:31], v[84:87], a[104:107], v[16:31]
    ds_read_b128 v[76:79], v255 offset:60416
    v_cmp_le_u32 vcc, 320, v242
    v_add_u32 v241, 7360, v242
    s_min_u32 s24, s16, 2
    v_cndmask_b32 v240, v242, v241, vcc
    s_waitcnt vmcnt(13) lgkmcnt(4)
    v_mfma_f32_32x32x16_bf16 v[0:15], v[88:91], a[108:111], v[0:15]
    ds_read_b128 v[80:83], v255 offset:61440
    buffer_load_dwordx4 a[156:159], v255, s[4:7], s68 offen offset:3072 sc1
    v_cmp_le_u32 vcc, 640, v242
    v_add_u32 v241, 4480, v242
    s_nop 0
    v_cndmask_b32 v240, v240, v241, vcc
    v_mfma_f32_32x32x16_bf16 v[16:31], v[92:95], a[108:111], v[16:31]
    ds_read_b128 v[84:87], v255 offset:62464
    s_mul_i32 s76, s18, 3
    s_add_u32 s76, s76, s24
    s_lshl_b32 s76, s76, 9
    s_add_u32 s76, s76, 262144
    s_waitcnt vmcnt(13) lgkmcnt(4)
    v_mfma_f32_32x32x16_bf16 v[0:15], v[64:67], a[112:115], v[0:15]
    ds_read_b128 v[88:91], v255 offset:63488
    s_mul_i32 s24, s16, 5136
    v_add_u32 v216, s24, v255
    v_and_b32 v201, 3, v254
    v_cmp_eq_u32 vcc, 0, v201
    v_mfma_f32_32x32x16_bf16 v[16:31], v[68:71], a[112:115], v[16:31]
    ds_read_b128 v[92:95], v255 offset:64512
    v_bfe_u32 v202, v254, 2, 2
    v_lshrrev_b32 v203, 5, v254
    v_lshl_add_u32 v202, v203, 2, v202
    v_cndmask_b32 v217, 0, 16, vcc
    s_waitcnt vmcnt(11) lgkmcnt(4)
    v_mfma_f32_32x32x16_bf16 v[0:15], v[72:75], a[116:119], v[0:15]
    ds_read_b128 v[64:67], v148 offset:0
    s_mul_i32 s70, s16, 4096
    s_add_u32 m0, s70, 131072
    s_add_u32 s71, s70, s69
    s_add_u32 s71, s71, 131072
    buffer_load_dwordx4 v255, s[4:7], s71 offen offset:0 sc1 lds
    v_mov_b32 v204, 5120
    v_mov_b32 v205, 2056
    v_cndmask_b32 v218, v204, v205, vcc
    v_and_b32 v203, 16, v254
    v_mfma_f32_32x32x16_bf16 v[16:31], v[76:79], a[116:119], v[16:31]
    ds_read_b128 v[68:71], v148 offset:1024
    v_cmp_eq_u32 vcc, 0, v203
    v_lshlrev_b32 v201, 3, v201
    v_add_u32 v201, 3072, v201
    v_cndmask_b32 v217, v217, 32, vcc
    s_waitcnt vmcnt(11) lgkmcnt(4)
    v_mfma_f32_32x32x16_bf16 v[0:15], v[80:83], a[120:123], v[0:15]
    ds_read_b128 v[72:75], v148 offset:2048
    buffer_load_dwordx4 v255, s[4:7], s71 offen offset:1024 sc1 lds
    s_lshl_b32 s28, s22, 1
    s_add_u32 s28, s28, s16
    s_lshl_b32 s28, s28, 3
    s_add_u32 s28, s28, s20
    v_mfma_f32_32x32x16_bf16 v[16:31], v[84:87], a[120:123], v[16:31]
    ds_read_b128 v[76:79], v148 offset:3072
    s_lshl_b32 s28, s28, 7
    s_add_u32 s28, s28, 30703616
    v_lshrrev_b32 v101, 3, v254
    v_lshlrev_b32 v101, 17, v101
    s_waitcnt vmcnt(10) lgkmcnt(4)
    v_mfma_f32_32x32x16_bf16 v[0:15], v[88:91], a[124:127], v[0:15]
    ds_read_b128 v[80:83], v148 offset:4096
    buffer_load_dwordx4 v255, s[4:7], s71 offen offset:2048 sc1 lds
    s_lshl_b32 s29, s21, 4
    s_add_u32 s29, s29, s18
    s_lshl_b32 s29, s29, 7
    s_add_u32 s29, s29, 29786112
    v_mfma_f32_32x32x16_bf16 v[16:31], v[92:95], a[124:127], v[16:31]
    ds_read_b128 v[84:87], v148 offset:5120
    v_add_u32 v101, s29, v101
    s_movk_i32 s27, 56
    v_cmp_le_u32 s[30:31], s27, v254
    v_mov_b32 v102, s28
    s_waitcnt vmcnt(10) lgkmcnt(4)
    v_mfma_f32_32x32x16_bf16 v[0:15], v[64:67], a[128:131], v[0:15]
    ds_read_b128 v[88:91], v148 offset:6144
    buffer_load_dwordx4 v255, s[4:7], s71 offen offset:3072 sc1 lds
    v_mov_b32 v104, 0
    v_cndmask_b32 v101, v101, v102, s[30:31]
    v_and_b32 v102, 0x70, v255
    v_add_u32 v101, v101, v102
    v_mfma_f32_32x32x16_bf16 v[16:31], v[68:71], a[128:131], v[16:31]
    ds_read_b128 v[92:95], v148 offset:7168
    buffer_store_dwordx4 v[104:107], v101, s[4:7], 0 offen sc1
    s_waitcnt vmcnt(11) lgkmcnt(4)
    v_mfma_f32_32x32x16_bf16 v[0:15], v[72:75], a[132:135], v[0:15]
    ds_read_b128 v[64:67], v148 offset:8192
    s_add_u32 m0, s70, 147456
    s_add_u32 s71, s71, 16384
    buffer_load_dwordx4 v255, s[4:7], s71 offen offset:0 sc1 lds
    v_cndmask_b32 v218, v218, v201, vcc
    v_mad_u32_u24 v218, v217, v202, v218
    v_add_u32 v218, s24, v218
    s_sub_i32 s80, 8, s21
    v_mfma_f32_32x32x16_bf16 v[16:31], v[76:79], a[132:135], v[16:31]
    ds_read_b128 v[68:71], v148 offset:9216
    s_max_i32 s80, s80, 0
    v_cmp_gt_u32 vcc, 32, v254
    v_mov_b32 v201, 0x3f803f80
    v_mov_b32 v202, 0x3f80
    s_waitcnt vmcnt(11) lgkmcnt(4)
    v_mfma_f32_32x32x16_bf16 v[0:15], v[80:83], a[136:139], v[0:15]
    ds_read_b128 v[72:75], v148 offset:10240
    buffer_load_dwordx4 v255, s[4:7], s71 offen offset:1024 sc1 lds
    v_cndmask_b32 v201, 0, v201, vcc
    v_cndmask_b32 v202, 0, v202, vcc
    v_accvgpr_write_b32 a252, v201
    v_accvgpr_write_b32 a253, v202
    v_mfma_f32_32x32x16_bf16 v[16:31], v[84:87], a[136:139], v[16:31]
    ds_read_b128 v[76:79], v148 offset:11264
    v_accvgpr_write_b32 a254, 0
    v_accvgpr_write_b32 a255, 0
    v_mov_b32 v202, 0
    v_mov_b32 v203, 0
    s_waitcnt vmcnt(11) lgkmcnt(4)
    v_mfma_f32_32x32x16_bf16 v[0:15], v[88:91], a[140:143], v[0:15]
    ds_read_b128 v[80:83], v148 offset:12288
    buffer_load_dwordx4 v255, s[4:7], s71 offen offset:2048 sc1 lds
    v_mov_b32 v230, 0
    v_mov_b32 v238, 0
    v_mov_b32 v231, 0
    v_mov_b32 v239, 0
    v_mfma_f32_32x32x16_bf16 v[16:31], v[92:95], a[140:143], v[16:31]
    ds_read_b128 v[84:87], v148 offset:13312
    s_mul_i32 s81, s21, 40960
    s_add_u32 s81, s81, 11534336
    s_lshl_b32 s24, s18, 9
    s_add_u32 s82, s81, s24
    s_waitcnt vmcnt(11) lgkmcnt(4)
    v_mfma_f32_32x32x16_bf16 v[0:15], v[64:67], a[144:147], v[0:15]
    ds_read_b128 v[88:91], v148 offset:14336
    buffer_load_dwordx4 v255, s[4:7], s71 offen offset:3072 sc1 lds
    s_add_u32 s82, s82, 32768
    s_lshl_b32 s24, s18, 10
    s_add_u32 s81, s81, s24
    s_sub_u32 s93, s84, 29786112
    v_mfma_f32_32x32x16_bf16 v[16:31], v[68:71], a[144:147], v[16:31]
    ds_read_b128 v[92:95], v148 offset:15360
    s_add_u32 s94, s93, 30048256
    s_lshl_b32 s95, s22, 2
    s_add_u32 s95, s95, s16
    s_lshl_b32 s95, s95, 9
    s_waitcnt vmcnt(11) lgkmcnt(4)
    v_mfma_f32_32x32x16_bf16 v[0:15], v[72:75], a[148:151], v[0:15]
    ds_read_b128 v[64:67], v148 offset:16384
    v_and_b32 v250, 3, v254
    v_lshlrev_b32 v250, 7, v250
    v_bfe_u32 v251, v254, 2, 1
    v_lshl_add_u32 v250, v251, 11, v250
    v_mfma_f32_32x32x16_bf16 v[16:31], v[76:79], a[148:151], v[16:31]
    ds_read_b128 v[68:71], v148 offset:17408
    v_and_b32 v242, 15, v254
    v_mul_u32_u24 v242, 1280, v242
    v_lshrrev_b32 v243, 4, v254
    v_lshl_add_u32 v243, v243, 3, v242
    s_waitcnt vmcnt(10) lgkmcnt(4)
    v_mfma_f32_32x32x16_bf16 v[0:15], v[80:83], a[152:155], v[0:15]
    ds_read_b128 v[72:75], v148 offset:18432
    v_and_b32 v106, 48, v254
    v_add_u32 v242, v106, v242
    s_lshl_b32 s26, s22, 1
    s_add_u32 s26, s26, s16
    v_mfma_f32_32x32x16_bf16 v[16:31], v[84:87], a[152:155], v[16:31]
    ds_read_b128 v[76:79], v148 offset:19456
    s_mul_i32 s26, s26, 20480
    s_mul_i32 s24, s20, 160
    s_add_u32 s26, s26, s24
    s_mov_b32 s66, s26
    s_waitcnt vmcnt(9) lgkmcnt(4)
    v_mfma_f32_32x32x16_bf16 v[0:15], v[88:91], a[156:159], v[0:15]
    ds_read_b128 v[80:83], v148 offset:20480
    v_mfma_f32_32x32x16_bf16 v[16:31], v[92:95], a[156:159], v[16:31]
    ds_read_b128 v[84:87], v148 offset:21504
    s_waitcnt lgkmcnt(4)
    v_mfma_f32_32x32x16_bf16 v[32:47], v[64:67], a[0:3], 0
    ds_read_b128 v[88:91], v148 offset:22528
    s_barrier
    s_mov_b64 exec, 255
    buffer_store_dwordx4 v[252:255], v255, s[4:7], s92 offen sc1
    s_mov_b64 exec, -1
    v_mfma_f32_32x32x16_bf16 v[32:47], v[68:71], a[4:7], v[32:47]
    ds_read_b128 v[92:95], v148 offset:23552
    s_waitcnt lgkmcnt(4)
    v_mfma_f32_32x32x16_bf16 v[32:47], v[72:75], a[8:11], v[32:47]
    ds_read_b128 v[64:67], v148 offset:24576
    s_mul_i32 s70, s16, 2048
    s_add_u32 m0, s70, 122880
    s_add_u32 s71, s70, s69
    s_add_u32 s71, s71, 122880
    buffer_load_dwordx4 v255, s[4:7], s71 offen offset:0 sc1 lds
    v_cvt_pk_bf16_f32 v128, v0, v1
    v_cvt_pk_bf16_f32 v129, v2, v3
    v_cvt_pk_bf16_f32 v130, v4, v5
    v_cvt_pk_bf16_f32 v131, v6, v7
    v_mfma_f32_32x32x16_bf16 v[32:47], v[76:79], a[12:15], v[32:47]
    ds_read_b128 v[68:71], v148 offset:25600
    buffer_store_dwordx4 v[128:131], v255, s[4:7], s83 offen offset:0 sc1
    v_cvt_pk_bf16_f32 v132, v8, v9
    v_cvt_pk_bf16_f32 v133, v10, v11
    v_cvt_pk_bf16_f32 v134, v12, v13
    s_waitcnt lgkmcnt(4)
    v_mfma_f32_32x32x16_bf16 v[32:47], v[80:83], a[16:19], v[32:47]
    ds_read_b128 v[72:75], v148 offset:26624
    buffer_load_dwordx4 v255, s[4:7], s71 offen offset:1024 sc1 lds
    v_cvt_pk_bf16_f32 v135, v14, v15
    buffer_store_dwordx4 v[132:135], v255, s[4:7], s83 offen offset:1024 sc1
    v_cvt_pk_bf16_f32 v136, v16, v17
    v_cvt_pk_bf16_f32 v137, v18, v19
    v_mfma_f32_32x32x16_bf16 v[32:47], v[84:87], a[20:23], v[32:47]
    ds_read_b128 v[76:79], v148 offset:27648
    v_cvt_pk_bf16_f32 v138, v20, v21
    v_cvt_pk_bf16_f32 v139, v22, v23
    buffer_store_dwordx4 v[136:139], v255, s[4:7], s83 offen offset:2048 sc1
    ds_write_b128 v154, v[128:131] offset:0
    s_waitcnt lgkmcnt(5)
    v_mfma_f32_32x32x16_bf16 v[32:47], v[88:91], a[24:27], v[32:47]
    ds_read_b128 v[80:83], v148 offset:28672
    ds_write_b128 v154, v[132:135] offset:1024
    ds_write_b128 v154, v[136:139] offset:2048
    ds_write_b64 v150, v[152:153] offset:5120
    v_mul_f32 v24, s90, v24
    v_mfma_f32_32x32x16_bf16 v[32:47], v[92:95], a[28:31], v[32:47]
    ds_read_b128 v[84:87], v148 offset:29696
    v_mul_f32 v25, s90, v25
    v_mul_f32 v26, s90, v26
    v_mul_f32 v27, s90, v27
    v_cvt_pk_bf16_f32 v24, v24, v25
    s_waitcnt lgkmcnt(8)
    v_mfma_f32_32x32x16_bf16 v[32:47], v[64:67], a[32:35], v[32:47]
    ds_read_b128 v[88:91], v148 offset:30720
    v_cvt_pk_bf16_f32 v25, v26, v27
    v_cmp_gt_u32 s[28:29], 32, v254
    s_nop 1
    v_cndmask_b32 v228, 0, v24, s[28:29]
    v_cndmask_b32 v236, v24, 0, s[28:29]
    v_mfma_f32_32x32x16_bf16 v[32:47], v[68:71], a[36:39], v[32:47]
    ds_read_b128 v[92:95], v148 offset:31744
    v_cndmask_b32 v229, 0, v25, s[28:29]
    v_cndmask_b32 v237, v25, 0, s[28:29]
    s_waitcnt lgkmcnt(8)
    v_mfma_f32_32x32x16_bf16 v[32:47], v[72:75], a[40:43], v[32:47]
    ds_read_b128 v[64:67], v148 offset:32768
    buffer_load_dwordx4 v[108:111], v144, s[48:51], s3 offen nt
    buffer_load_dwordx4 v[112:115], v145, s[48:51], s3 offen nt
    buffer_load_dwordx4 v[116:119], v146, s[48:51], s3 offen nt
    buffer_load_dwordx4 v[120:123], v147, s[48:51], s3 offen nt
    buffer_load_dwordx4 v[124:127], v151, s[48:51], s3 offen nt
    s_mov_b32 s32, 0xffffffff
    s_mov_b32 s33, 0xfffffff0
    s_mov_b32 s34, 0xfffffffe
    s_mov_b32 s35, 0xffffffe0
    v_mfma_f32_32x32x16_bf16 v[32:47], v[76:79], a[44:47], v[32:47]
    ds_read_b128 v[68:71], v148 offset:33792
    s_mov_b32 s36, 0xfffffffc
    s_mov_b32 s37, 0xffffffc0
    s_mov_b32 s38, 0xfffffff8
    s_mov_b32 s39, 0xffffff80
    s_waitcnt lgkmcnt(7)
    v_mfma_f32_32x32x16_bf16 v[32:47], v[80:83], a[48:51], v[32:47]
    ds_read_b128 v[72:75], v148 offset:34816
    s_mov_b32 s40, 0xffffff00
    s_mov_b32 s41, 0xfffff000
    s_mov_b32 s42, 0xfffffe00
    s_mov_b32 s43, 0xffffe000
    s_waitcnt lgkmcnt(4)
    v_mfma_f32_32x32x16_bf16 v[32:47], v[84:87], a[52:55], v[32:47]
    ds_read_b128 v[76:79], v148 offset:35840
    s_mov_b32 s44, 0xfffffc00
    s_mov_b32 s45, 0xffffc000
    s_mov_b32 s46, 0xfffff800
    s_mov_b32 s47, 0xffff8000
    v_mfma_f32_32x32x16_bf16 v[32:47], v[88:91], a[56:59], v[32:47]
    ds_read_b128 v[80:83], v148 offset:36864
    s_mov_b32 s48, 0xffff0000
    s_mov_b32 s49, 0xfff00000
    s_mov_b32 s50, 0xfffe0000
    s_mov_b32 s51, 0xffe00000
    s_waitcnt lgkmcnt(4)
    v_mfma_f32_32x32x16_bf16 v[32:47], v[92:95], a[60:63], v[32:47]
    ds_read_b128 v[84:87], v148 offset:37888
    s_mov_b32 s52, 0xfffc0000
    s_mov_b32 s53, 0xffc00000
    s_mov_b32 s54, 0xfff80000
    s_mov_b32 s55, 0xff800000
    v_mfma_f32_32x32x16_bf16 v[32:47], v[64:67], a[64:67], v[32:47]
    ds_read_b128 v[88:91], v148 offset:38912
    s_mov_b32 s56, 0xff000000
    s_mov_b32 s57, 0xf0000000
    s_mov_b32 s58, 0xfe000000
    s_mov_b32 s59, 0xe0000000
    s_waitcnt lgkmcnt(4)
    v_mfma_f32_32x32x16_bf16 v[32:47], v[68:71], a[68:71], v[32:47]
    ds_read_b128 v[92:95], v148 offset:39936
    s_mov_b32 s60, 0xfc000000
    s_mov_b32 s61, 0xc0000000
    s_mov_b32 s62, 0xf8000000
    s_mov_b32 s63, 0x80000000
    v_mfma_f32_32x32x16_bf16 v[32:47], v[72:75], a[72:75], v[32:47]
    ds_read_b128 v[64:67], v148 offset:40960
    v_mov_b32 v204, 0xffff
    v_mov_b32 v205, 0xffff0000
    v_cndmask_b32 v208, 0, v204, s[32:33]
    v_cndmask_b32 v206, 0, v205, s[34:35]
    s_waitcnt lgkmcnt(4)
    v_mfma_f32_32x32x16_bf16 v[32:47], v[76:79], a[76:79], v[32:47]
    ds_read_b128 v[68:71], v148 offset:41984
    v_or_b32 v208, v208, v206
    v_cndmask_b32 v209, 0, v204, s[36:37]
    v_cndmask_b32 v206, 0, v205, s[38:39]
    v_or_b32 v209, v209, v206
    v_mfma_f32_32x32x16_bf16 v[32:47], v[80:83], a[80:83], v[32:47]
    ds_read_b128 v[72:75], v148 offset:43008
    v_cndmask_b32 v210, 0, v204, s[40:41]
    v_cndmask_b32 v206, 0, v205, s[42:43]
    v_or_b32 v210, v210, v206
    v_cndmask_b32 v211, 0, v204, s[44:45]
    s_waitcnt lgkmcnt(4)
    v_mfma_f32_32x32x16_bf16 v[32:47], v[84:87], a[84:87], v[32:47]
    ds_read_b128 v[76:79], v148 offset:44032
    v_cndmask_b32 v206, 0, v205, s[46:47]
    v_or_b32 v211, v211, v206
    v_cndmask_b32 v212, 0, v204, s[48:49]
    v_cndmask_b32 v206, 0, v205, s[50:51]
    v_mfma_f32_32x32x16_bf16 v[32:47], v[88:91], a[88:91], v[32:47]
    ds_read_b128 v[80:83], v148 offset:45056
    s_waitcnt vmcnt(5)
    s_mov_b64 exec, 255
    buffer_store_dwordx4 v[252:255], v255, s[4:7], s84 offen sc1
    s_mov_b64 exec, -1
    v_or_b32 v212, v212, v206
    v_cndmask_b32 v213, 0, v204, s[52:53]
    v_cndmask_b32 v206, 0, v205, s[54:55]
    v_or_b32 v213, v213, v206
    s_waitcnt lgkmcnt(4)
    v_mfma_f32_32x32x16_bf16 v[32:47], v[92:95], a[92:95], v[32:47]
    ds_read_b128 v[84:87], v148 offset:46080
    v_cndmask_b32 v214, 0, v204, s[56:57]
    v_cndmask_b32 v206, 0, v205, s[58:59]
    v_or_b32 v214, v214, v206
    v_cndmask_b32 v215, 0, v204, s[60:61]
    v_mfma_f32_32x32x16_bf16 v[32:47], v[64:67], a[96:99], v[32:47]
    ds_read_b128 v[88:91], v148 offset:47104
    v_cndmask_b32 v206, 0, v205, s[62:63]
    v_or_b32 v215, v215, v206
    v_lshrrev_b32 v163, 5, v254
    v_mul_u32_u24 v163, 24064, v163
    s_waitcnt lgkmcnt(4)
    v_mfma_f32_32x32x16_bf16 v[32:47], v[68:71], a[100:103], v[32:47]
    ds_read_b128 v[92:95], v148 offset:48128
    v_add_u32 v163, v163, v255
    s_mov_b32 s67, s96
    s_mul_i32 s26, s22, 40960
    s_mul_i32 s24, s16, 4096
    v_mfma_f32_32x32x16_bf16 v[32:47], v[72:75], a[104:107], v[32:47]
    ds_read_b128 v[64:67], v148 offset:49152
    s_add_u32 s26, s26, s24
    s_add_u32 s26, s26, 11534336
    s_add_u32 s24, s16, 1
    s_bfe_u32 s27, s24, 0x10001
    s_waitcnt lgkmcnt(4)
    v_mfma_f32_32x32x16_bf16 v[32:47], v[76:79], a[108:111], v[32:47]
    ds_read_b128 v[68:71], v148 offset:50176
    s_mul_i32 s27, s27, 40960
    s_and_b32 s24, s24, 1
    s_lshl_b32 s24, s24, 8
    s_add_u32 s24, s24, s27
    v_mfma_f32_32x32x16_bf16 v[32:47], v[80:83], a[112:115], v[32:47]
    ds_read_b128 v[72:75], v148 offset:51200
    s_add_u32 s96, s26, s24
    s_add_u32 s24, s16, 2
    s_bfe_u32 s27, s24, 0x10001
    s_mul_i32 s27, s27, 40960
    s_waitcnt lgkmcnt(4)
    v_mfma_f32_32x32x16_bf16 v[32:47], v[84:87], a[116:119], v[32:47]
    ds_read_b128 v[76:79], v148 offset:52224
    s_and_b32 s24, s24, 1
    s_lshl_b32 s24, s24, 8
    s_add_u32 s24, s24, s27
    s_add_u32 s97, s26, s24
    v_mfma_f32_32x32x16_bf16 v[32:47], v[88:91], a[120:123], v[32:47]
    ds_read_b128 v[80:83], v148 offset:53248
    s_add_u32 s24, s16, 3
    s_bfe_u32 s27, s24, 0x10001
    s_mul_i32 s27, s27, 40960
    s_and_b32 s24, s24, 1
    s_waitcnt lgkmcnt(4)
    v_mfma_f32_32x32x16_bf16 v[32:47], v[92:95], a[124:127], v[32:47]
    ds_read_b128 v[84:87], v148 offset:54272
    s_lshl_b32 s24, s24, 8
    s_add_u32 s24, s24, s27
    s_add_u32 s98, s26, s24
    s_add_u32 s24, s16, 4
    v_mfma_f32_32x32x16_bf16 v[32:47], v[64:67], a[128:131], v[32:47]
    ds_read_b128 v[88:91], v148 offset:55296
    s_bfe_u32 s27, s24, 0x10001
    s_mul_i32 s27, s27, 40960
    s_and_b32 s24, s24, 1
    s_lshl_b32 s24, s24, 8
    s_waitcnt lgkmcnt(4)
    v_mfma_f32_32x32x16_bf16 v[32:47], v[68:71], a[132:135], v[32:47]
    ds_read_b128 v[92:95], v148 offset:56320
    s_add_u32 s24, s24, s27
    s_add_u32 s99, s26, s24
    v_mov_b32 v184, 0
    v_mov_b32 v185, 0
    v_mfma_f32_32x32x16_bf16 v[32:47], v[72:75], a[136:139], v[32:47]
    s_barrier
    ds_read_b128 v[64:67], v149 offset:0
    v_mov_b32 v186, 0
    v_mov_b32 v187, 0
    v_mov_b32 v188, 0
    v_mov_b32 v189, 0
    s_waitcnt lgkmcnt(4)
    v_mfma_f32_32x32x16_bf16 v[32:47], v[76:79], a[140:143], v[32:47]
    ds_read_b128 v[68:71], v149 offset:1024
    v_mov_b32 v190, 0
    v_mov_b32 v191, 0
    v_mov_b32 v192, 0
    v_mov_b32 v193, 0
    v_mfma_f32_32x32x16_bf16 v[32:47], v[80:83], a[144:147], v[32:47]
    ds_read_b128 v[72:75], v149 offset:2048
    v_mov_b32 v194, 0
    v_mov_b32 v195, 0
    v_mov_b32 v196, 0
    v_mov_b32 v197, 0
    s_waitcnt lgkmcnt(4)
    v_mfma_f32_32x32x16_bf16 v[32:47], v[84:87], a[148:151], v[32:47]
    ds_read_b128 v[76:79], v149 offset:3072
    v_mov_b32 v198, 0
    v_mov_b32 v199, 0
    s_add_u32 s92, s92, 32768
    v_lshrrev_b32 v206, 1, v254
    v_mfma_f32_32x32x16_bf16 v[32:47], v[88:91], a[152:155], v[32:47]
    ds_read_b128 v[80:83], v149 offset:4096
    v_lshlrev_b32 v206, 4, v206
    v_and_b32 v207, 1, v254
    v_lshl_add_u32 v206, v207, 9, v206
    v_and_b32 v207, 0x7ffffc00, v156
    s_waitcnt lgkmcnt(4)
    v_mfma_f32_32x32x16_bf16 v[32:47], v[92:95], a[156:159], v[32:47]
    ds_read_b128 v[84:87], v149 offset:5120
    v_or_b32 v206, v206, v207
    v_mov_b32 v207, v157
    v_mfma_f32_32x32x16_bf16 v[48:63], v[64:67], a[32:35], 0
    ds_read_b128 v[88:91], v149 offset:6144
    s_waitcnt lgkmcnt(4)
    v_mfma_f32_32x32x16_bf16 v[48:63], v[68:71], a[36:39], v[48:63]
    ds_read_b128 v[92:95], v149 offset:7168
    v_mfma_f32_32x32x16_bf16 v[48:63], v[72:75], a[40:43], v[48:63]
    ds_read_b128 v[64:67], v149 offset:8192
    buffer_load_dword v244, v157, s[4:7], s86 offen sc1
    s_nop 0
    v_cvt_pk_bf16_f32 v140, v32, v33
    v_cvt_pk_bf16_f32 v141, v34, v35
    v_cvt_pk_bf16_f32 v142, v36, v37
    v_cvt_pk_bf16_f32 v143, v38, v39
    s_waitcnt lgkmcnt(4)
    v_mfma_f32_32x32x16_bf16 v[48:63], v[76:79], a[44:47], v[48:63]
    ds_read_b128 v[68:71], v149 offset:9216
    buffer_store_dwordx4 v[140:143], v255, s[4:7], s83 offen offset:3072 sc1
    v_cvt_pk_bf16_f32 v144, v40, v41
    v_cvt_pk_bf16_f32 v145, v42, v43
    v_cvt_pk_bf16_f32 v146, v44, v45
    v_mfma_f32_32x32x16_bf16 v[48:63], v[80:83], a[48:51], v[48:63]
    ds_read_b128 v[72:75], v149 offset:10240
    v_cvt_pk_bf16_f32 v147, v46, v47
    s_add_u32 s83, s83, 4096
    buffer_store_dwordx4 v[144:147], v255, s[4:7], s83 offen offset:0 sc1
    ds_write_b128 v155, v[140:143] offset:3072
    ds_write_b128 v155, v[144:147] offset:4096
    s_waitcnt lgkmcnt(6)
    v_mfma_f32_32x32x16_bf16 v[48:63], v[84:87], a[52:55], v[48:63]
    ds_read_b128 v[76:79], v149 offset:11264
    v_mfma_f32_32x32x16_bf16 v[48:63], v[88:91], a[56:59], v[48:63]
    ds_read_b128 v[80:83], v149 offset:12288
    s_waitcnt lgkmcnt(6)
    v_mfma_f32_32x32x16_bf16 v[48:63], v[92:95], a[60:63], v[48:63]
    ds_read_b128 v[84:87], v149 offset:13312
    v_mfma_f32_32x32x16_bf16 v[48:63], v[64:67], a[64:67], v[48:63]
    ds_read_b128 v[88:91], v149 offset:14336
    s_waitcnt lgkmcnt(6)
    v_mfma_f32_32x32x16_bf16 v[48:63], v[68:71], a[68:71], v[48:63]
    ds_read_b128 v[92:95], v149 offset:15360
    v_mfma_f32_32x32x16_bf16 v[48:63], v[72:75], a[72:75], v[48:63]
    ds_read_b128 v[64:67], v149 offset:16384
    s_waitcnt lgkmcnt(4)
    v_mfma_f32_32x32x16_bf16 v[48:63], v[76:79], a[76:79], v[48:63]
    ds_read_b128 v[68:71], v149 offset:17408
    v_mfma_f32_32x32x16_bf16 v[48:63], v[80:83], a[80:83], v[48:63]
    ds_read_b128 v[72:75], v149 offset:18432
    s_waitcnt lgkmcnt(4)
    v_mfma_f32_32x32x16_bf16 v[48:63], v[84:87], a[84:87], v[48:63]
    ds_read_b128 v[76:79], v149 offset:19456
    v_mfma_f32_32x32x16_bf16 v[48:63], v[88:91], a[88:91], v[48:63]
    ds_read_b128 v[80:83], v149 offset:20480
    s_waitcnt lgkmcnt(4)
    v_mfma_f32_32x32x16_bf16 v[48:63], v[92:95], a[92:95], v[48:63]
    ds_read_b128 v[84:87], v149 offset:21504
    v_mfma_f32_32x32x16_bf16 v[48:63], v[64:67], a[96:99], v[48:63]
    ds_read_b128 v[88:91], v149 offset:22528
    s_waitcnt lgkmcnt(4)
    v_mfma_f32_32x32x16_bf16 v[48:63], v[68:71], a[100:103], v[48:63]
    ds_read_b128 v[92:95], v149 offset:23552
    v_mfma_f32_32x32x16_bf16 v[48:63], v[72:75], a[104:107], v[48:63]
    ds_read_b128 v[64:67], v149 offset:24576
    s_waitcnt lgkmcnt(4)
    v_mfma_f32_32x32x16_bf16 v[48:63], v[76:79], a[108:111], v[48:63]
    ds_read_b128 v[68:71], v149 offset:25600
    v_mfma_f32_32x32x16_bf16 v[48:63], v[80:83], a[112:115], v[48:63]
    ds_read_b128 v[72:75], v149 offset:26624
    s_waitcnt lgkmcnt(4)
    v_mfma_f32_32x32x16_bf16 v[48:63], v[84:87], a[116:119], v[48:63]
    ds_read_b128 v[76:79], v149 offset:27648
    v_mfma_f32_32x32x16_bf16 v[48:63], v[88:91], a[120:123], v[48:63]
    ds_read_b128 v[80:83], v149 offset:28672
    s_waitcnt lgkmcnt(4)
    v_mfma_f32_32x32x16_bf16 v[48:63], v[92:95], a[124:127], v[48:63]
    ds_read_b128 v[84:87], v149 offset:29696
    v_mfma_f32_32x32x16_bf16 v[48:63], v[64:67], a[128:131], v[48:63]
    ds_read_b128 v[88:91], v149 offset:30720
    s_waitcnt vmcnt(2)
    v_cmp_ne_u32 vcc, s64, v244
    s_cbranch_vccz L_pdone_k
    s_mov_b32 s65, 0x20000
L_poll_k:
    buffer_load_dword v244, v157, s[4:7], s86 offen sc1
    s_waitcnt vmcnt(0)
    v_cmp_ne_u32 vcc, s64, v244
    s_cbranch_vccz L_pdone_k
    s_sub_u32 s65, s65, 1
    s_cbranch_scc0 L_poll_k
L_pdone_k:
    s_mov_b32 s24, s87
    s_mov_b32 s25, s88
    s_mov_b32 m0, s25
    s_nop 0
    buffer_load_dwordx4 v156, s[4:7], s24 offen offset:0 sc1 lds
    buffer_load_dwordx4 v156, s[4:7], s24 offen offset:1024 sc1 lds
    buffer_load_dwordx4 v156, s[4:7], s24 offen offset:2048 sc1 lds
    s_add_u32 s24, s24, 81920
    s_add_u32 s25, s25, 5136
    s_mov_b32 m0, s25
    s_nop 0
    buffer_load_dwordx4 v156, s[4:7], s24 offen offset:0 sc1 lds
    buffer_load_dwordx4 v156, s[4:7], s24 offen offset:1024 sc1 lds
    buffer_load_dwordx4 v156, s[4:7], s24 offen offset:2048 sc1 lds
    s_waitcnt lgkmcnt(4)
    v_mfma_f32_32x32x16_bf16 v[48:63], v[68:71], a[132:135], v[48:63]
    ds_read_b128 v[92:95], v149 offset:31744
    v_mfma_f32_32x32x16_bf16 v[48:63], v[72:75], a[136:139], v[48:63]
    ds_read_b128 v[64:67], v148 offset:57344
    s_waitcnt lgkmcnt(4)
    v_mfma_f32_32x32x16_bf16 v[48:63], v[76:79], a[140:143], v[48:63]
    ds_read_b128 v[68:71], v148 offset:58368
    v_mfma_f32_32x32x16_bf16 v[48:63], v[80:83], a[144:147], v[48:63]
    ds_read_b128 v[72:75], v148 offset:59392
    s_waitcnt vmcnt(6)
    s_mov_b64 exec, 255
    buffer_store_dwordx4 v[252:255], v255, s[4:7], s85 offen sc1
    s_mov_b64 exec, -1
    s_waitcnt lgkmcnt(4)
    v_mfma_f32_32x32x16_bf16 v[48:63], v[84:87], a[148:151], v[48:63]
    ds_read_b128 v[76:79], v148 offset:60416
    v_mfma_f32_32x32x16_bf16 v[48:63], v[88:91], a[152:155], v[48:63]
    ds_read_b128 v[80:83], v148 offset:61440
    s_waitcnt lgkmcnt(4)
    v_mfma_f32_32x32x16_bf16 v[48:63], v[92:95], a[156:159], v[48:63]
    ds_read_b128 v[84:87], v148 offset:62464
    v_mfma_f32_32x32x16_bf16 v[48:63], v[64:67], a[0:3], v[48:63]
    ds_read_b128 v[88:91], v148 offset:63488
    s_waitcnt lgkmcnt(4)
    v_mfma_f32_32x32x16_bf16 v[48:63], v[68:71], a[4:7], v[48:63]
    ds_read_b128 v[92:95], v148 offset:64512
    v_mfma_f32_32x32x16_bf16 v[48:63], v[72:75], a[8:11], v[48:63]
    s_waitcnt lgkmcnt(3)
    v_mfma_f32_32x32x16_bf16 v[48:63], v[76:79], a[12:15], v[48:63]
    v_mfma_f32_32x32x16_bf16 v[48:63], v[80:83], a[16:19], v[48:63]
    s_waitcnt lgkmcnt(1)
    v_mfma_f32_32x32x16_bf16 v[48:63], v[84:87], a[20:23], v[48:63]
    v_mfma_f32_32x32x16_bf16 v[48:63], v[88:91], a[24:27], v[48:63]
    s_waitcnt lgkmcnt(0)
    v_mfma_f32_32x32x16_bf16 v[48:63], v[92:95], a[28:31], v[48:63]
    s_mov_b32 exec_hi, 0xff01f000
    buffer_load_dword v245, v219, s[4:7], s89 offen sc1
    s_mov_b64 exec, -1
    s_add_u32 s86, s86, 131072
    s_add_u32 s87, s87, 3072
    s_add_u32 s88, s88, 3072
    s_nop 5
    v_pk_mul_f32 v[48:49], v[48:49], s[90:91]
    v_cvt_pk_bf16_f32 v224, v48, v49
    v_pk_mul_f32 v[50:51], v[50:51], s[90:91]
    v_cvt_pk_bf16_f32 v225, v50, v51
    v_pk_mul_f32 v[52:53], v[52:53], s[90:91]
    v_cvt_pk_bf16_f32 v226, v52, v53
    v_pk_mul_f32 v[54:55], v[54:55], s[90:91]
    v_cvt_pk_bf16_f32 v227, v54, v55
    v_pk_mul_f32 v[56:57], v[56:57], s[90:91]
    v_cvt_pk_bf16_f32 v232, v56, v57
    v_pk_mul_f32 v[58:59], v[58:59], s[90:91]
    v_cvt_pk_bf16_f32 v233, v58, v59
    v_pk_mul_f32 v[60:61], v[60:61], s[90:91]
    v_cvt_pk_bf16_f32 v234, v60, v61
    v_pk_mul_f32 v[62:63], v[62:63], s[90:91]
    v_cvt_pk_bf16_f32 v235, v62, v63
    s_cmp_ge_u32 s67, 0x40000000
    s_cbranch_scc1 L_no_c
    v_and_b32 v3, 3, v254
    v_bfe_u32 v4, v254, 2, 2
    v_bfe_u32 v5, v254, 4, 2
    v_lshrrev_b32 v13, 1, v5
    v_lshl_add_u32 v13, v13, 4, v4
    v_and_b32 v14, 1, v5
    v_lshl_add_u32 v13, v14, 2, v13
    v_mul_u32_u24 v13, 176, v13
    s_mul_i32 s24, s16, 5632
    s_add_u32 s24, s24, 65536
    v_add_u32 v13, s24, v13
    v_lshl_add_u32 v14, v3, 4, v13
    v_lshl_add_u32 v15, v3, 3, v13
    v_accvgpr_read_b32 v8, a232
    v_accvgpr_read_b32 v9, a233
    v_accvgpr_read_b32 v10, a234
    v_accvgpr_read_b32 v11, a235
    v_accvgpr_read_b32 v12, a236
    ds_write_b128 v8, v[108:111]
    ds_write_b128 v9, v[112:115]
    ds_write_b128 v10, v[116:119]
    ds_write_b128 v11, v[120:123]
    ds_write_b128 v12, v[124:127]
    ds_read_b64_tr_b16 a[52:53], v14 offset:0
    ds_read_b64_tr_b16 a[54:55], v14 offset:1408
    ds_read_b64_tr_b16 a[56:57], v14 offset:8
    ds_read_b64_tr_b16 a[58:59], v14 offset:1416
    ds_read_b64_tr_b16 a[60:61], v14 offset:64
    ds_read_b64_tr_b16 a[62:63], v14 offset:1472
    ds_read_b64_tr_b16 a[64:65], v14 offset:72
    ds_read_b64_tr_b16 a[66:67], v14 offset:1480
    ds_read_b64_tr_b16 a[68:69], v15 offset:128
    ds_read_b64_tr_b16 a[70:71], v15 offset:1536
L_no_c:
    s_waitcnt lgkmcnt(0)
    s_waitcnt vmcnt(2)
    buffer_load_dword v244, v157, s[4:7], s86 offen sc1
    s_barrier
    s_getpc_b64 s[68:69]
L_pc2:
    s_lshr_b32 s24, s2, 3
    s_lshl_b32 s24, s24, 2
    s_add_u32 s24, s24, s16
    s_lshl_b32 s24, s24, 3
    v_lshrrev_b32 v248, 3, v254
    v_add_u32 v248, s24, v248
    v_and_b32 v248, 255, v248
    v_lshlrev_b32 v248, 7, v248
    v_min_u32 v248, L_main_end-L_pc2, v248
    ds_read_b128 a[72:75], v216 offset:41088
    ds_read_b128 a[100:103], v216 offset:43136
    ds_read_b128 a[76:79], v216 offset:0
    ds_read_b128 a[104:107], v216 offset:2048
    s_cmp_lg_u32 s80, 0
    s_cbranch_scc1 L_neg_0
L_nret_0:
    s_waitcnt lgkmcnt(2)
    v_mfma_f32_32x32x16_bf16 v[128:143], a[72:75], v[224:227], 0
    v_mad_u32_u24 v220, v217, 0, v218
    v_mad_u32_u24 v221, v217, 8, v218
    v_mad_u32_u24 v222, v217, 16, v218
    v_mad_u32_u24 v223, v217, 24, v218
    v_mfma_f32_32x32x16_bf16 v[128:143], a[100:103], v[228:231], v[128:143]
    ds_read_b128 a[80:83], v216 offset:5136
    ds_read_b128 a[108:111], v216 offset:7184
    s_waitcnt lgkmcnt(2)
    v_mfma_f32_32x32x16_bf16 v[0:15], a[76:79], v[224:227], v[184:199]
    v_mfma_f32_32x32x16_bf16 v[0:15], a[104:107], v[228:231], v[0:15]
    ds_read_b128 a[72:75], v216 offset:10272
    ds_read_b128 a[112:115], v216 offset:12320
    s_mov_b32 exec_hi, 0xff01f000
    s_waitcnt vmcnt(1)
    v_cmp_ne_u32 vcc, s64, v245
    s_cbranch_vccz L_pdone_bg
    s_mov_b32 s65, 0x20000
L_poll_bg:
    buffer_load_dword v246, v219, s[4:7], s89 offen sc1
    s_waitcnt vmcnt(0)
    v_cmp_ne_u32 vcc, s64, v246
    s_cbranch_vccz L_pdone_bg
    s_sub_u32 s65, s65, 1
    s_cbranch_scc0 L_poll_bg
L_pdone_bg:
    s_mov_b64 exec, -1
    buffer_load_dwordx4 a[20:23], v240, s[4:7], s75 offen sc1
    s_cmp_eq_u32 s80, 1
    s_cbranch_scc1 L_zero_0_1
L_zret_0_1:
    s_waitcnt lgkmcnt(2)
    v_mfma_f32_32x32x16_bf16 v[16:31], a[80:83], v[224:227], v[184:199]
    v_mfma_f32_32x32x16_bf16 v[16:31], a[108:111], v[228:231], v[16:31]
    ds_read_b128 a[76:79], v216 offset:15408
    ds_read_b128 a[116:119], v216 offset:17456
    v_cndmask_b32 v0, v0, v128, s[32:33]
    v_cndmask_b32 v1, v1, v129, s[34:35]
    v_cndmask_b32 v2, v2, v130, s[36:37]
    v_cndmask_b32 v3, v3, v131, s[38:39]
    s_cmp_eq_u32 s80, 2
    s_cbranch_scc1 L_zero_0_2
L_zret_0_2:
    s_waitcnt lgkmcnt(2)
    v_mfma_f32_32x32x16_bf16 v[32:47], a[72:75], v[224:227], v[184:199]
    v_cndmask_b32 v4, v4, v132, s[40:41]
    v_cndmask_b32 v5, v5, v133, s[42:43]
    v_cndmask_b32 v6, v6, v134, s[44:45]
    v_cndmask_b32 v7, v7, v135, s[46:47]
    v_cndmask_b32 v8, v8, v136, s[48:49]
    v_cndmask_b32 v9, v9, v137, s[50:51]
    v_mfma_f32_32x32x16_bf16 v[32:47], a[112:115], v[228:231], v[32:47]
    ds_read_b128 a[80:83], v216 offset:20544
    ds_read_b128 a[120:123], v216 offset:22592
    s_add_u32 s75, s75, 15360
    buffer_load_dwordx4 a[24:27], v240, s[4:7], s75 offen sc1
    v_cndmask_b32 v10, v10, v138, s[52:53]
    v_cndmask_b32 v11, v11, v139, s[54:55]
    v_cndmask_b32 v12, v12, v140, s[56:57]
    v_cndmask_b32 v13, v13, v141, s[58:59]
    s_cmp_eq_u32 s80, 3
    s_cbranch_scc1 L_zero_0_3
L_zret_0_3:
    s_waitcnt lgkmcnt(2)
    v_mfma_f32_32x32x16_bf16 v[48:63], a[76:79], v[224:227], v[184:199]
    v_cndmask_b32 v14, v14, v142, s[60:61]
    v_cndmask_b32 v15, v15, v143, s[62:63]
    v_max_f32 v204, v0, v1
    v_max_f32 v205, v2, v3
    v_max3_f32 v204, v204, v4, v5
    v_max3_f32 v205, v205, v6, v7
    v_mfma_f32_32x32x16_bf16 v[48:63], a[116:119], v[228:231], v[48:63]
    ds_read_b128 a[72:75], v216 offset:25680
    ds_read_b128 a[124:127], v216 offset:27728
    v_max3_f32 v204, v204, v8, v9
    v_max3_f32 v205, v205, v10, v11
    v_max3_f32 v204, v204, v12, v13
    v_max3_f32 v205, v205, v14, v15
    s_cmp_eq_u32 s80, 4
    s_cbranch_scc1 L_zero_0_4
L_zret_0_4:
    s_waitcnt lgkmcnt(2)
    v_mfma_f32_32x32x16_bf16 v[64:79], a[80:83], v[224:227], v[184:199]
    v_max3_f32 v204, v204, v16, v17
    v_max3_f32 v205, v205, v18, v19
    v_max3_f32 v204, v204, v20, v21
    v_max3_f32 v205, v205, v22, v23
    v_max3_f32 v204, v204, v24, v25
    v_max3_f32 v205, v205, v26, v27
    v_mfma_f32_32x32x16_bf16 v[64:79], a[120:123], v[228:231], v[64:79]
    ds_read_b128 a[76:79], v216 offset:30816
    ds_read_b128 a[128:131], v216 offset:32864
    s_add_u32 s75, s75, 15360
    buffer_load_dwordx4 a[28:31], v240, s[4:7], s75 offen sc1
    v_max3_f32 v204, v204, v28, v29
    v_max3_f32 v205, v205, v30, v31
    v_max3_f32 v204, v204, v32, v33
    v_max3_f32 v205, v205, v34, v35
    s_cmp_eq_u32 s80, 5
    s_cbranch_scc1 L_zero_0_5
L_zret_0_5:
    s_waitcnt lgkmcnt(2)
    v_mfma_f32_32x32x16_bf16 v[80:95], a[72:75], v[224:227], v[184:199]
    v_max3_f32 v204, v204, v36, v37
    v_max3_f32 v205, v205, v38, v39
    v_max3_f32 v204, v204, v40, v41
    v_max3_f32 v205, v205, v42, v43
    v_max3_f32 v204, v204, v44, v45
    v_max3_f32 v205, v205, v46, v47
    v_mfma_f32_32x32x16_bf16 v[80:95], a[124:127], v[228:231], v[80:95]
    ds_read_b128 a[80:83], v216 offset:35952
    ds_read_b128 a[132:135], v216 offset:38000
    v_max3_f32 v204, v204, v48, v49
    v_max3_f32 v205, v205, v50, v51
    v_max3_f32 v204, v204, v52, v53
    v_max3_f32 v205, v205, v54, v55
    s_cmp_eq_u32 s80, 6
    s_cbranch_scc1 L_zero_0_6
L_zret_0_6:
    s_waitcnt lgkmcnt(2)
    v_mfma_f32_32x32x16_bf16 v[96:111], a[76:79], v[224:227], v[184:199]
    v_max3_f32 v204, v204, v56, v57
    v_max3_f32 v205, v205, v58, v59
    v_max3_f32 v204, v204, v60, v61
    v_max3_f32 v205, v205, v62, v63
    v_max3_f32 v204, v204, v64, v65
    v_max3_f32 v205, v205, v66, v67
    v_mfma_f32_32x32x16_bf16 v[96:111], a[128:131], v[228:231], v[96:111]
    s_add_u32 s75, s75, 15360
    buffer_load_dwordx4 a[32:35], v240, s[4:7], s75 offen sc1
    v_max3_f32 v204, v204, v68, v69
    v_max3_f32 v205, v205, v70, v71
    v_max3_f32 v204, v204, v72, v73
    v_max3_f32 v205, v205, v74, v75
    s_cmp_eq_u32 s80, 7
    s_cbranch_scc1 L_zero_0_7
L_zret_0_7:
    s_waitcnt lgkmcnt(0)
    v_mfma_f32_32x32x16_bf16 v[112:127], a[80:83], v[224:227], v[184:199]
    v_max3_f32 v204, v204, v76, v77
    v_max3_f32 v205, v205, v78, v79
    v_max3_f32 v204, v204, v80, v81
    v_max3_f32 v205, v205, v82, v83
    v_max3_f32 v204, v204, v84, v85
    v_max3_f32 v205, v205, v86, v87
    v_mfma_f32_32x32x16_bf16 v[112:127], a[132:135], v[228:231], v[112:127]
    s_waitcnt vmcnt(4)
    v_cmp_ne_u32 vcc, s64, v244
    s_cbranch_vccz L_pdone_vn
    s_mov_b32 s65, 0x20000
L_poll_vn:
    buffer_load_dword v244, v207, s[4:7], s86 offen sc1
    s_waitcnt vmcnt(0)
    v_cmp_ne_u32 vcc, s64, v244
    s_cbranch_vccz L_pdone_vn
    s_sub_u32 s65, s65, 1
    s_cbranch_scc0 L_poll_vn
L_pdone_vn:
    s_mov_b32 s24, s87
    s_mov_b32 s25, s88
    s_mov_b32 m0, s25
    s_nop 0
    buffer_load_dwordx4 v206, s[4:7], s24 offen offset:0 sc1 lds
    buffer_load_dwordx4 v206, s[4:7], s24 offen offset:1024 sc1 lds
    s_add_u32 s24, s24, 81920
    s_add_u32 s25, s25, 5136
    s_mov_b32 m0, s25
    s_nop 0
    buffer_load_dwordx4 v206, s[4:7], s24 offen offset:0 sc1 lds
    buffer_load_dwordx4 v206, s[4:7], s24 offen offset:1024 sc1 lds
    v_max3_f32 v204, v204, v88, v89
    v_max3_f32 v205, v205, v90, v91
    v_max3_f32 v204, v204, v92, v93
    v_max3_f32 v205, v205, v94, v95
    v_max3_f32 v204, v204, v96, v97
    v_max3_f32 v205, v205, v98, v99
    v_max3_f32 v204, v204, v100, v101
    v_max3_f32 v205, v205, v102, v103
    v_max3_f32 v204, v204, v104, v105
    v_max3_f32 v205, v205, v106, v107
    v_max3_f32 v204, v204, v108, v109
    v_max3_f32 v205, v205, v110, v111
    v_max3_f32 v204, v204, v112, v113
    v_max3_f32 v205, v205, v114, v115
    v_max3_f32 v204, v204, v116, v117
    v_max3_f32 v205, v205, v118, v119
    v_max3_f32 v204, v204, v120, v121
    v_max3_f32 v205, v205, v122, v123
    v_max3_f32 v204, v204, v124, v125
    v_max3_f32 v205, v205, v126, v127
    v_max_f32 v204, v204, v205
    v_mov_b32 v205, v204
    s_nop 1
    v_permlane32_swap_b32 v204, v205
    v_max_f32 v162, v204, v205
    v_cvt_pk_bf16_f32 v205, -v162, -v162
    v_and_b32 v206, 0xffff0000, v205
    v_add_f32 v204, v162, v206
    v_cvt_pk_bf16_f32 v207, -v204, -v204
    v_and_b32 v206, 0xffff0000, v207
    v_add_f32 v204, v204, v206
    v_alignbit_b32 v200, v207, v205, 16
    v_cvt_pk_bf16_f32 v201, -v204, -v204
    v_pk_add_f32 v[0:1], v[0:1], v[162:163] op_sel_hi:[1,0] neg_lo:[0,1] neg_hi:[0,1]
    v_pk_add_f32 v[2:3], v[2:3], v[162:163] op_sel_hi:[1,0] neg_lo:[0,1] neg_hi:[0,1]
    v_pk_add_f32 v[4:5], v[4:5], v[162:163] op_sel_hi:[1,0] neg_lo:[0,1] neg_hi:[0,1]
    v_pk_add_f32 v[6:7], v[6:7], v[162:163] op_sel_hi:[1,0] neg_lo:[0,1] neg_hi:[0,1]
    v_pk_add_f32 v[8:9], v[8:9], v[162:163] op_sel_hi:[1,0] neg_lo:[0,1] neg_hi:[0,1]
    v_pk_add_f32 v[10:11], v[10:11], v[162:163] op_sel_hi:[1,0] neg_lo:[0,1] neg_hi:[0,1]
    v_pk_add_f32 v[12:13], v[12:13], v[162:163] op_sel_hi:[1,0] neg_lo:[0,1] neg_hi:[0,1]
    v_pk_add_f32 v[14:15], v[14:15], v[162:163] op_sel_hi:[1,0] neg_lo:[0,1] neg_hi:[0,1]
    v_mfma_f32_32x32x16_bf16 v[16:31], a[252:255], v[200:203], v[16:31]
    v_exp_f32 v0, v0
    v_exp_f32 v1, v1
    v_exp_f32 v2, v2
    v_exp_f32 v3, v3
    v_exp_f32 v4, v4
    v_exp_f32 v5, v5
    v_exp_f32 v6, v6
    v_exp_f32 v7, v7
    buffer_load_dwordx4 a[160:163], v255, s[4:7], s77 offen offset:0 sc1
    v_cvt_pk_bf16_f32 v0, v0, v1
    v_cvt_pk_bf16_f32 v1, v2, v3
    v_cvt_pk_bf16_f32 v2, v4, v5
    v_cvt_pk_bf16_f32 v3, v6, v7
    v_and_b32 v136, v0, v208
    v_and_b32 v137, v1, v209
    v_and_b32 v138, v2, v210
    v_and_b32 v139, v3, v211
    v_xor_b32 v128, v0, v136
    v_xor_b32 v129, v1, v137
    v_xor_b32 v130, v2, v138
    v_xor_b32 v131, v3, v139
    v_exp_f32 v8, v8
    v_exp_f32 v9, v9
    v_exp_f32 v10, v10
    v_exp_f32 v11, v11
    v_exp_f32 v12, v12
    v_exp_f32 v13, v13
    v_mfma_f32_32x32x16_bf16 v[32:47], a[252:255], v[200:203], v[32:47]
    v_exp_f32 v14, v14
    v_exp_f32 v15, v15
    buffer_store_dwordx4 a[52:55], v255, s[4:7], s67 offen offset:0 sc1
    buffer_load_dwordx4 a[164:167], v255, s[4:7], s77 offen offset:1024 sc1
    v_cvt_pk_bf16_f32 v4, v8, v9
    v_cvt_pk_bf16_f32 v5, v10, v11
    v_cvt_pk_bf16_f32 v6, v12, v13
    v_cvt_pk_bf16_f32 v7, v14, v15
    v_and_b32 v140, v4, v212
    v_and_b32 v141, v5, v213
    v_and_b32 v142, v6, v214
    v_and_b32 v143, v7, v215
    v_xor_b32 v132, v4, v140
    v_xor_b32 v133, v5, v141
    v_xor_b32 v134, v6, v142
    v_xor_b32 v135, v7, v143
    v_exp_f32 v16, v16
    v_exp_f32 v17, v17
    v_exp_f32 v18, v18
    v_exp_f32 v19, v19
    v_exp_f32 v20, v20
    v_exp_f32 v21, v21
    v_exp_f32 v22, v22
    v_exp_f32 v23, v23
    buffer_load_dwordx4 a[168:171], v255, s[4:7], s77 offen offset:2048 sc1
    v_cvt_pk_bf16_f32 v16, v16, v17
    v_cvt_pk_bf16_f32 v17, v18, v19
    v_cvt_pk_bf16_f32 v18, v20, v21
    v_cvt_pk_bf16_f32 v19, v22, v23
    v_exp_f32 v24, v24
    v_exp_f32 v25, v25
    v_exp_f32 v26, v26
    v_exp_f32 v27, v27
    v_exp_f32 v28, v28
    v_exp_f32 v29, v29
    v_mfma_f32_32x32x16_bf16 v[48:63], a[252:255], v[200:203], v[48:63]
    v_exp_f32 v30, v30
    v_exp_f32 v31, v31
    buffer_store_dwordx4 a[56:59], v255, s[4:7], s67 offen offset:1024 sc1
    buffer_load_dwordx4 a[172:175], v255, s[4:7], s77 offen offset:3072 sc1
    v_cvt_pk_bf16_f32 v20, v24, v25
    v_cvt_pk_bf16_f32 v21, v26, v27
    v_cvt_pk_bf16_f32 v22, v28, v29
    v_cvt_pk_bf16_f32 v23, v30, v31
    v_exp_f32 v32, v32
    v_exp_f32 v33, v33
    v_exp_f32 v34, v34
    v_exp_f32 v35, v35
    v_exp_f32 v36, v36
    v_exp_f32 v37, v37
    v_exp_f32 v38, v38
    v_exp_f32 v39, v39
    s_add_u32 s77, s77, 4096
    buffer_load_dwordx4 a[176:179], v255, s[4:7], s77 offen offset:0 sc1
    v_cvt_pk_bf16_f32 v32, v32, v33
    v_cvt_pk_bf16_f32 v33, v34, v35
    v_cvt_pk_bf16_f32 v34, v36, v37
    v_cvt_pk_bf16_f32 v35, v38, v39
    v_exp_f32 v40, v40
    v_exp_f32 v41, v41
    v_exp_f32 v42, v42
    v_exp_f32 v43, v43
    v_exp_f32 v44, v44
    v_exp_f32 v45, v45
    v_mfma_f32_32x32x16_bf16 v[64:79], a[252:255], v[200:203], v[64:79]
    v_exp_f32 v46, v46
    v_exp_f32 v47, v47
    buffer_store_dwordx4 a[60:63], v255, s[4:7], s67 offen offset:2048 sc1
    buffer_load_dwordx4 a[180:183], v255, s[4:7], s77 offen offset:1024 sc1
    v_cvt_pk_bf16_f32 v36, v40, v41
    v_cvt_pk_bf16_f32 v37, v42, v43
    v_cvt_pk_bf16_f32 v38, v44, v45
    v_cvt_pk_bf16_f32 v39, v46, v47
    v_exp_f32 v48, v48
    v_exp_f32 v49, v49
    v_exp_f32 v50, v50
    v_exp_f32 v51, v51
    v_exp_f32 v52, v52
    v_exp_f32 v53, v53
    v_exp_f32 v54, v54
    v_exp_f32 v55, v55
    buffer_load_dwordx4 a[184:187], v255, s[4:7], s77 offen offset:2048 sc1
    v_cvt_pk_bf16_f32 v48, v48, v49
    v_cvt_pk_bf16_f32 v49, v50, v51
    v_cvt_pk_bf16_f32 v50, v52, v53
    v_cvt_pk_bf16_f32 v51, v54, v55
    v_exp_f32 v56, v56
    v_exp_f32 v57, v57
    v_exp_f32 v58, v58
    v_exp_f32 v59, v59
    v_exp_f32 v60, v60
    v_exp_f32 v61, v61
    v_mfma_f32_32x32x16_bf16 v[80:95], a[252:255], v[200:203], v[80:95]
    v_exp_f32 v62, v62
    v_exp_f32 v63, v63
    buffer_store_dwordx4 a[64:67], v255, s[4:7], s67 offen offset:3072 sc1
    buffer_load_dwordx4 a[188:191], v255, s[4:7], s77 offen offset:3072 sc1
    v_cvt_pk_bf16_f32 v52, v56, v57
    v_cvt_pk_bf16_f32 v53, v58, v59
    v_cvt_pk_bf16_f32 v54, v60, v61
    v_cvt_pk_bf16_f32 v55, v62, v63
    v_exp_f32 v64, v64
    v_exp_f32 v65, v65
    v_exp_f32 v66, v66
    v_exp_f32 v67, v67
    v_exp_f32 v68, v68
    v_exp_f32 v69, v69
    v_exp_f32 v70, v70
    v_exp_f32 v71, v71
    s_waitcnt vmcnt(12)
    s_barrier
    ds_read_b64_tr_b16 v[168:169], v220 offset:41088
    ds_read_b64_tr_b16 v[170:171], v221 offset:41088
    ds_read_b64_tr_b16 v[172:173], v220 offset:0
    ds_read_b64_tr_b16 v[174:175], v221 offset:0
    s_add_u32 s77, s77, 4096
    buffer_load_dwordx4 a[192:195], v255, s[4:7], s77 offen offset:0 sc1
    buffer_load_dwordx4 a[196:199], v255, s[4:7], s77 offen offset:1024 sc1
    v_cvt_pk_bf16_f32 v64, v64, v65
    v_cvt_pk_bf16_f32 v65, v66, v67
    v_cvt_pk_bf16_f32 v66, v68, v69
    v_cvt_pk_bf16_f32 v67, v70, v71
    v_exp_f32 v72, v72
    v_exp_f32 v73, v73
    s_waitcnt lgkmcnt(2)
    v_mfma_f32_32x32x16_bf16 v[144:159], v[168:171], v[136:139], 0
    ds_read_b64_tr_b16 v[176:177], v222 offset:41088
    ds_read_b64_tr_b16 v[178:179], v223 offset:41088
    v_exp_f32 v74, v74
    v_exp_f32 v75, v75
    v_exp_f32 v76, v76
    v_exp_f32 v77, v77
    v_mfma_f32_32x32x16_bf16 v[96:111], a[252:255], v[200:203], v[96:111]
    v_exp_f32 v78, v78
    v_exp_f32 v79, v79
    s_add_u32 s67, s67, 4096
    buffer_store_dwordx4 a[68:71], v255, s[4:7], s67 offen offset:0 sc1
    buffer_load_dwordx4 a[200:203], v255, s[4:7], s77 offen offset:2048 sc1
    buffer_load_dwordx4 a[204:207], v255, s[4:7], s77 offen offset:3072 sc1
    v_cvt_pk_bf16_f32 v68, v72, v73
    v_cvt_pk_bf16_f32 v69, v74, v75
    v_cvt_pk_bf16_f32 v70, v76, v77
    v_cvt_pk_bf16_f32 v71, v78, v79
    v_exp_f32 v80, v80
    v_exp_f32 v81, v81
    s_waitcnt lgkmcnt(2)
    v_mfma_f32_32x32x16_bf16 v[144:159], v[172:175], v[128:131], v[144:159]
    ds_read_b64_tr_b16 v[180:181], v222 offset:0
    ds_read_b64_tr_b16 v[182:183], v223 offset:0
    v_exp_f32 v82, v82
    v_exp_f32 v83, v83
    v_exp_f32 v84, v84
    v_exp_f32 v85, v85
    s_waitcnt lgkmcnt(2)
    v_mfma_f32_32x32x16_bf16 v[144:159], v[176:179], v[140:143], v[144:159]
    ds_read_b64_tr_b16 v[168:169], v220 offset:5136
    ds_read_b64_tr_b16 v[170:171], v221 offset:5136
    v_exp_f32 v86, v86
    v_exp_f32 v87, v87
    s_add_u32 s77, s77, 4096
    buffer_load_dwordx4 a[208:211], v255, s[4:7], s77 offen offset:0 sc1
    buffer_load_dwordx4 a[212:215], v255, s[4:7], s77 offen offset:1024 sc1
    v_cvt_pk_bf16_f32 v80, v80, v81
    v_cvt_pk_bf16_f32 v81, v82, v83
    v_cvt_pk_bf16_f32 v82, v84, v85
    v_cvt_pk_bf16_f32 v83, v86, v87
    v_exp_f32 v88, v88
    v_exp_f32 v89, v89
    s_waitcnt lgkmcnt(2)
    v_mfma_f32_32x32x16_bf16 v[144:159], v[180:183], v[132:135], v[144:159]
    ds_read_b64_tr_b16 v[172:173], v222 offset:5136
    ds_read_b64_tr_b16 v[174:175], v223 offset:5136
    v_exp_f32 v90, v90
    v_exp_f32 v91, v91
    v_exp_f32 v92, v92
    v_exp_f32 v93, v93
    v_mfma_f32_32x32x16_bf16 v[112:127], a[252:255], v[200:203], v[112:127]
    v_exp_f32 v94, v94
    v_exp_f32 v95, v95
    buffer_load_dwordx4 a[216:219], v255, s[4:7], s77 offen offset:2048 sc1
    buffer_load_dwordx4 a[220:223], v255, s[4:7], s77 offen offset:3072 sc1
    v_cvt_pk_bf16_f32 v84, v88, v89
    v_cvt_pk_bf16_f32 v85, v90, v91
    v_cvt_pk_bf16_f32 v86, v92, v93
    v_cvt_pk_bf16_f32 v87, v94, v95
    v_exp_f32 v96, v96
    v_exp_f32 v97, v97
    s_waitcnt lgkmcnt(2)
    v_mfma_f32_32x32x16_bf16 v[144:159], v[168:171], v[16:19], v[144:159]
    ds_read_b64_tr_b16 v[176:177], v220 offset:10272
    ds_read_b64_tr_b16 v[178:179], v221 offset:10272
    v_exp_f32 v98, v98
    v_exp_f32 v99, v99
    v_exp_f32 v100, v100
    v_exp_f32 v101, v101
    s_waitcnt lgkmcnt(2)
    v_mfma_f32_32x32x16_bf16 v[144:159], v[172:175], v[20:23], v[144:159]
    ds_read_b64_tr_b16 v[180:181], v222 offset:10272
    ds_read_b64_tr_b16 v[182:183], v223 offset:10272
    v_exp_f32 v102, v102
    v_exp_f32 v103, v103
    s_add_u32 s77, s77, 4096
    buffer_load_dwordx4 a[224:227], v255, s[4:7], s77 offen offset:0 sc1
    buffer_load_dwordx4 a[228:231], v255, s[4:7], s77 offen offset:1024 sc1
    v_cvt_pk_bf16_f32 v96, v96, v97
    v_cvt_pk_bf16_f32 v97, v98, v99
    v_cvt_pk_bf16_f32 v98, v100, v101
    v_cvt_pk_bf16_f32 v99, v102, v103
    v_exp_f32 v104, v104
    v_exp_f32 v105, v105
    s_waitcnt lgkmcnt(2)
    v_mfma_f32_32x32x16_bf16 v[144:159], v[176:179], v[32:35], v[144:159]
    ds_read_b64_tr_b16 v[168:169], v220 offset:15408
    ds_read_b64_tr_b16 v[170:171], v221 offset:15408
    v_exp_f32 v106, v106
    v_exp_f32 v107, v107
    v_exp_f32 v108, v108
    v_exp_f32 v109, v109
    s_waitcnt lgkmcnt(2)
    v_mfma_f32_32x32x16_bf16 v[144:159], v[180:183], v[36:39], v[144:159]
    ds_read_b64_tr_b16 v[172:173], v222 offset:15408
    ds_read_b64_tr_b16 v[174:175], v223 offset:15408
    v_exp_f32 v110, v110
    v_exp_f32 v111, v111
    buffer_load_dwordx4 a[232:235], v255, s[4:7], s77 offen offset:2048 sc1
    buffer_load_dwordx4 a[236:239], v255, s[4:7], s77 offen offset:3072 sc1
    v_cvt_pk_bf16_f32 v100, v104, v105
    v_cvt_pk_bf16_f32 v101, v106, v107
    v_cvt_pk_bf16_f32 v102, v108, v109
    v_cvt_pk_bf16_f32 v103, v110, v111
    ds_read_b128 a[72:75], v216 offset:42112
    ds_read_b128 a[76:79], v216 offset:1024
    v_exp_f32 v112, v112
    v_exp_f32 v113, v113
    s_waitcnt lgkmcnt(4)
    v_mfma_f32_32x32x16_bf16 v[144:159], v[168:171], v[48:51], v[144:159]
    ds_read_b64_tr_b16 v[176:177], v220 offset:20544
    ds_read_b64_tr_b16 v[178:179], v221 offset:20544
    v_exp_f32 v114, v114
    v_exp_f32 v115, v115
    v_exp_f32 v116, v116
    v_exp_f32 v117, v117
    s_waitcnt lgkmcnt(4)
    v_mfma_f32_32x32x16_bf16 v[144:159], v[172:175], v[52:55], v[144:159]
    ds_read_b64_tr_b16 v[180:181], v222 offset:20544
    ds_read_b64_tr_b16 v[182:183], v223 offset:20544
    v_exp_f32 v118, v118
    v_exp_f32 v119, v119
    s_add_u32 s77, s77, 4096
    buffer_load_dwordx4 a[0:3], v255, s[4:7], s77 offen offset:0 sc1
    buffer_load_dwordx4 a[4:7], v255, s[4:7], s77 offen offset:1024 sc1
    v_cvt_pk_bf16_f32 v112, v112, v113
    v_cvt_pk_bf16_f32 v113, v114, v115
    v_cvt_pk_bf16_f32 v114, v116, v117
    v_cvt_pk_bf16_f32 v115, v118, v119
    v_exp_f32 v120, v120
    v_exp_f32 v121, v121
    s_waitcnt lgkmcnt(2)
    v_mfma_f32_32x32x16_bf16 v[144:159], v[176:179], v[64:67], v[144:159]
    ds_read_b64_tr_b16 v[168:169], v220 offset:25680
    ds_read_b64_tr_b16 v[170:171], v221 offset:25680
    v_exp_f32 v122, v122
    v_exp_f32 v123, v123
    v_exp_f32 v124, v124
    v_exp_f32 v125, v125
    s_waitcnt lgkmcnt(2)
    v_mfma_f32_32x32x16_bf16 v[144:159], v[180:183], v[68:71], v[144:159]
    ds_read_b64_tr_b16 v[172:173], v222 offset:25680
    ds_read_b64_tr_b16 v[174:175], v223 offset:25680
    v_exp_f32 v126, v126
    v_exp_f32 v127, v127
    buffer_load_dwordx4 a[8:11], v255, s[4:7], s77 offen offset:2048 sc1
    buffer_load_dwordx4 a[12:15], v255, s[4:7], s77 offen offset:3072 sc1
    v_cvt_pk_bf16_f32 v116, v120, v121
    v_cvt_pk_bf16_f32 v117, v122, v123
    v_cvt_pk_bf16_f32 v118, v124, v125
    v_cvt_pk_bf16_f32 v119, v126, v127
    s_waitcnt lgkmcnt(2)
    v_mfma_f32_32x32x16_bf16 v[144:159], v[168:171], v[80:83], v[144:159]
    ds_read_b64_tr_b16 v[176:177], v220 offset:30816
    ds_read_b64_tr_b16 v[178:179], v221 offset:30816
    s_waitcnt lgkmcnt(2)
    v_mfma_f32_32x32x16_bf16 v[144:159], v[172:175], v[84:87], v[144:159]
    ds_read_b64_tr_b16 v[180:181], v222 offset:30816
    ds_read_b64_tr_b16 v[182:183], v223 offset:30816
    s_waitcnt lgkmcnt(2)
    v_mfma_f32_32x32x16_bf16 v[144:159], v[176:179], v[96:99], v[144:159]
    ds_read_b64_tr_b16 v[168:169], v220 offset:35952
    ds_read_b64_tr_b16 v[170:171], v221 offset:35952
    s_waitcnt lgkmcnt(2)
    v_mfma_f32_32x32x16_bf16 v[144:159], v[180:183], v[100:103], v[144:159]
    ds_read_b64_tr_b16 v[172:173], v222 offset:35952
    ds_read_b64_tr_b16 v[174:175], v223 offset:35952
    s_waitcnt lgkmcnt(2)
    v_mfma_f32_32x32x16_bf16 v[144:159], v[168:171], v[112:115], v[144:159]
    s_waitcnt lgkmcnt(0)
    v_mfma_f32_32x32x16_bf16 v[144:159], v[172:175], v[116:119], v[144:159]
    s_cmp_lg_u32 s80, 0
    s_cbranch_scc1 L_neg_1
L_nret_1:
    v_mfma_f32_32x32x16_bf16 v[128:143], a[72:75], v[232:235], 0
    v_mad_u32_u24 v220, v217, 32, v218
    v_mad_u32_u24 v221, v217, 40, v218
    v_mad_u32_u24 v222, v217, 48, v218
    v_mad_u32_u24 v223, v217, 56, v218
    v_mfma_f32_32x32x16_bf16 v[128:143], a[100:103], v[236:239], v[128:143]
    ds_read_b128 a[80:83], v216 offset:6160
    s_nop 2
    v_rcp_f32 v160, v156
    s_nop 0
    v_mul_f32 v144, v144, v160
    v_mul_f32 v145, v145, v160
    v_mul_f32 v146, v146, v160
    v_mul_f32 v147, v147, v160
    v_mfma_f32_32x32x16_bf16 v[0:15], a[76:79], v[232:235], v[184:199]
    v_mul_f32 v148, v148, v160
    v_mul_f32 v149, v149, v160
    v_mul_f32 v150, v150, v160
    v_mul_f32 v151, v151, v160
    v_mul_f32 v152, v152, v160
    v_mul_f32 v153, v153, v160
    v_mfma_f32_32x32x16_bf16 v[0:15], a[104:107], v[236:239], v[0:15]
    ds_read_b128 a[72:75], v216 offset:11296
    s_add_u32 s77, s77, 4096
    buffer_load_dwordx4 a[16:19], v255, s[4:7], s77 offen offset:0 sc1
    v_mul_f32 v154, v154, v160
    v_mul_f32 v155, v155, v160
    v_cvt_pk_bf16_f32 v164, v144, v145
    v_cvt_pk_bf16_f32 v165, v146, v147
    v_cvt_pk_bf16_f32 v166, v148, v149
    s_cmp_eq_u32 s80, 1
    s_cbranch_scc1 L_zero_1_1
L_zret_1_1:
    s_waitcnt lgkmcnt(1)
    v_mfma_f32_32x32x16_bf16 v[16:31], a[80:83], v[232:235], v[184:199]
    v_cvt_pk_bf16_f32 v167, v150, v151
    buffer_store_dwordx4 v[164:167], v255, s[4:7], s81 offen sc1
    s_add_u32 s81, s81, 16384
    v_cvt_pk_bf16_f32 v240, v152, v153
    v_cvt_pk_bf16_f32 v241, v154, v155
    v_mfma_f32_32x32x16_bf16 v[16:31], a[108:111], v[236:239], v[16:31]
    ds_read_b128 a[76:79], v216 offset:16432
    v_cndmask_b32 v0, v0, v128, s[32:33]
    v_cndmask_b32 v1, v1, v129, s[34:35]
    v_cndmask_b32 v2, v2, v130, s[36:37]
    v_cndmask_b32 v3, v3, v131, s[38:39]
    v_cndmask_b32 v4, v4, v132, s[40:41]
    s_cmp_eq_u32 s80, 2
    s_cbranch_scc1 L_zero_1_2
L_zret_1_2:
    s_waitcnt lgkmcnt(1)
    v_mfma_f32_32x32x16_bf16 v[32:47], a[72:75], v[232:235], v[184:199]
    v_cndmask_b32 v5, v5, v133, s[42:43]
    v_cndmask_b32 v6, v6, v134, s[44:45]
    v_cndmask_b32 v7, v7, v135, s[46:47]
    v_cndmask_b32 v8, v8, v136, s[48:49]
    v_cndmask_b32 v9, v9, v137, s[50:51]
    v_cndmask_b32 v10, v10, v138, s[52:53]
    v_mfma_f32_32x32x16_bf16 v[32:47], a[112:115], v[236:239], v[32:47]
    ds_read_b128 a[80:83], v216 offset:21568
    buffer_load_dwordx4 a[36:39], v163, s[4:7], s76 offen sc1
    v_cndmask_b32 v11, v11, v139, s[54:55]
    v_cndmask_b32 v12, v12, v140, s[56:57]
    v_cndmask_b32 v13, v13, v141, s[58:59]
    v_cndmask_b32 v14, v14, v142, s[60:61]
    v_cndmask_b32 v15, v15, v143, s[62:63]
    s_cmp_eq_u32 s80, 3
    s_cbranch_scc1 L_zero_1_3
L_zret_1_3:
    s_waitcnt lgkmcnt(1)
    v_mfma_f32_32x32x16_bf16 v[48:63], a[76:79], v[232:235], v[184:199]
    v_max_f32 v204, v0, v1
    v_max_f32 v205, v2, v3
    v_max3_f32 v204, v204, v4, v5
    v_max3_f32 v205, v205, v6, v7
    v_max3_f32 v204, v204, v8, v9
    v_max3_f32 v205, v205, v10, v11
    v_mfma_f32_32x32x16_bf16 v[48:63], a[116:119], v[236:239], v[48:63]
    ds_read_b128 a[72:75], v216 offset:26704
    v_max3_f32 v204, v204, v12, v13
    v_max3_f32 v205, v205, v14, v15
    v_max3_f32 v204, v204, v16, v17
    v_max3_f32 v205, v205, v18, v19
    v_max3_f32 v204, v204, v20, v21
    s_cmp_eq_u32 s80, 4
    s_cbranch_scc1 L_zero_1_4
L_zret_1_4:
    s_waitcnt lgkmcnt(1)
    v_mfma_f32_32x32x16_bf16 v[64:79], a[80:83], v[232:235], v[184:199]
    v_max3_f32 v205, v205, v22, v23
    v_max3_f32 v204, v204, v24, v25
    v_max3_f32 v205, v205, v26, v27
    v_max3_f32 v204, v204, v28, v29
    v_max3_f32 v205, v205, v30, v31
    v_max3_f32 v204, v204, v32, v33
    v_mfma_f32_32x32x16_bf16 v[64:79], a[120:123], v[236:239], v[64:79]
    ds_read_b128 a[76:79], v216 offset:31840
    buffer_load_dwordx4 a[240:243], v242, s[8:11], s66 offen
    v_max3_f32 v205, v205, v34, v35
    v_max3_f32 v204, v204, v36, v37
    v_max3_f32 v205, v205, v38, v39
    v_max3_f32 v204, v204, v40, v41
    v_max3_f32 v205, v205, v42, v43
    s_cmp_eq_u32 s80, 5
    s_cbranch_scc1 L_zero_1_5
L_zret_1_5:
    s_waitcnt lgkmcnt(1)
    v_mfma_f32_32x32x16_bf16 v[80:95], a[72:75], v[232:235], v[184:199]
    v_max3_f32 v204, v204, v44, v45
    v_max3_f32 v205, v205, v46, v47
    v_max3_f32 v204, v204, v48, v49
    v_max3_f32 v205, v205, v50, v51
    v_max3_f32 v204, v204, v52, v53
    v_max3_f32 v205, v205, v54, v55
    v_mfma_f32_32x32x16_bf16 v[80:95], a[124:127], v[236:239], v[80:95]
    ds_read_b128 a[80:83], v216 offset:36976
    v_max3_f32 v204, v204, v56, v57
    v_max3_f32 v205, v205, v58, v59
    v_max3_f32 v204, v204, v60, v61
    v_max3_f32 v205, v205, v62, v63
    v_max3_f32 v204, v204, v64, v65
    s_cmp_eq_u32 s80, 6
    s_cbranch_scc1 L_zero_1_6
L_zret_1_6:
    s_waitcnt lgkmcnt(1)
    v_mfma_f32_32x32x16_bf16 v[96:111], a[76:79], v[232:235], v[184:199]
    v_max3_f32 v205, v205, v66, v67
    v_max3_f32 v204, v204, v68, v69
    v_max3_f32 v205, v205, v70, v71
    v_max3_f32 v204, v204, v72, v73
    v_max3_f32 v205, v205, v74, v75
    v_max3_f32 v204, v204, v76, v77
    v_mfma_f32_32x32x16_bf16 v[96:111], a[128:131], v[236:239], v[96:111]
    buffer_load_dwordx4 a[244:247], v242, s[8:11], s66 offen offset:64
    v_max3_f32 v205, v205, v78, v79
    v_max3_f32 v204, v204, v80, v81
    v_max3_f32 v205, v205, v82, v83
    v_max3_f32 v204, v204, v84, v85
    v_max3_f32 v205, v205, v86, v87
    s_cmp_eq_u32 s80, 7
    s_cbranch_scc1 L_zero_1_7
L_zret_1_7:
    s_waitcnt lgkmcnt(0)
    v_mfma_f32_32x32x16_bf16 v[112:127], a[80:83], v[232:235], v[184:199]
    v_max3_f32 v204, v204, v88, v89
    v_max3_f32 v205, v205, v90, v91
    v_max3_f32 v204, v204, v92, v93
    v_max3_f32 v205, v205, v94, v95
    v_mfma_f32_32x32x16_bf16 v[112:127], a[132:135], v[236:239], v[112:127]
    v_max3_f32 v204, v204, v96, v97
    v_max3_f32 v205, v205, v98, v99
    v_max3_f32 v204, v204, v100, v101
    v_max3_f32 v205, v205, v102, v103
    v_max3_f32 v204, v204, v104, v105
    ds_read_b64_tr_b16 v[168:169], v220 offset:41088
    ds_read_b64_tr_b16 v[170:171], v221 offset:41088
    ds_read_b64_tr_b16 v[172:173], v220 offset:0
    ds_read_b64_tr_b16 v[174:175], v221 offset:0
    v_max3_f32 v205, v205, v106, v107
    v_max3_f32 v204, v204, v108, v109
    v_max3_f32 v205, v205, v110, v111
    v_max3_f32 v204, v204, v112, v113
    v_max3_f32 v205, v205, v114, v115
    v_max3_f32 v204, v204, v116, v117
    v_max3_f32 v205, v205, v118, v119
    v_max3_f32 v204, v204, v120, v121
    v_max3_f32 v205, v205, v122, v123
    v_max3_f32 v204, v204, v124, v125
    v_max3_f32 v205, v205, v126, v127
    v_max_f32 v204, v204, v205
    v_mov_b32 v205, v204
    s_nop 1
    v_permlane32_swap_b32 v204, v205
    v_max_f32 v162, v204, v205
    v_cvt_pk_bf16_f32 v205, -v162, -v162
    v_and_b32 v206, 0xffff0000, v205
    v_add_f32 v204, v162, v206
    v_cvt_pk_bf16_f32 v207, -v204, -v204
    v_and_b32 v206, 0xffff0000, v207
    v_add_f32 v204, v204, v206
    v_alignbit_b32 v200, v207, v205, 16
    v_cvt_pk_bf16_f32 v201, -v204, -v204
    v_pk_add_f32 v[0:1], v[0:1], v[162:163] op_sel_hi:[1,0] neg_lo:[0,1] neg_hi:[0,1]
    v_pk_add_f32 v[2:3], v[2:3], v[162:163] op_sel_hi:[1,0] neg_lo:[0,1] neg_hi:[0,1]
    v_pk_add_f32 v[4:5], v[4:5], v[162:163] op_sel_hi:[1,0] neg_lo:[0,1] neg_hi:[0,1]
    v_pk_add_f32 v[6:7], v[6:7], v[162:163] op_sel_hi:[1,0] neg_lo:[0,1] neg_hi:[0,1]
    v_pk_add_f32 v[8:9], v[8:9], v[162:163] op_sel_hi:[1,0] neg_lo:[0,1] neg_hi:[0,1]
    v_pk_add_f32 v[10:11], v[10:11], v[162:163] op_sel_hi:[1,0] neg_lo:[0,1] neg_hi:[0,1]
    v_pk_add_f32 v[12:13], v[12:13], v[162:163] op_sel_hi:[1,0] neg_lo:[0,1] neg_hi:[0,1]
    v_pk_add_f32 v[14:15], v[14:15], v[162:163] op_sel_hi:[1,0] neg_lo:[0,1] neg_hi:[0,1]
    v_mfma_f32_32x32x16_bf16 v[16:31], a[252:255], v[200:203], v[16:31]
    v_exp_f32 v0, v0
    v_exp_f32 v1, v1
    v_exp_f32 v2, v2
    v_exp_f32 v3, v3
    v_exp_f32 v4, v4
    v_exp_f32 v5, v5
    v_exp_f32 v6, v6
    v_exp_f32 v7, v7
    buffer_load_dwordx2 a[248:249], v243, s[8:11], s66 offen offset:128
    s_add_u32 s76, s76, 49152
    buffer_load_dwordx4 a[40:43], v163, s[4:7], s76 offen sc1
    v_cvt_pk_bf16_f32 v0, v0, v1
    v_cvt_pk_bf16_f32 v1, v2, v3
    v_cvt_pk_bf16_f32 v2, v4, v5
    v_cvt_pk_bf16_f32 v3, v6, v7
    v_and_b32 v136, v0, v208
    v_and_b32 v137, v1, v209
    v_and_b32 v138, v2, v210
    v_and_b32 v139, v3, v211
    v_xor_b32 v128, v0, v136
    v_xor_b32 v129, v1, v137
    v_xor_b32 v130, v2, v138
    v_xor_b32 v131, v3, v139
    v_exp_f32 v8, v8
    v_exp_f32 v9, v9
    s_waitcnt lgkmcnt(2)
    v_mfma_f32_32x32x16_bf16 v[144:159], v[168:171], v[136:139], 0
    ds_read_b64_tr_b16 v[176:177], v222 offset:41088
    ds_read_b64_tr_b16 v[178:179], v223 offset:41088
    v_exp_f32 v10, v10
    v_exp_f32 v11, v11
    v_exp_f32 v12, v12
    v_exp_f32 v13, v13
    v_mfma_f32_32x32x16_bf16 v[32:47], a[252:255], v[200:203], v[32:47]
    v_exp_f32 v14, v14
    v_exp_f32 v15, v15
    s_add_u32 s76, s76, 49152
    buffer_load_dwordx4 a[44:47], v163, s[4:7], s76 offen sc1
    s_add_u32 s76, s76, 49152
    buffer_load_dwordx4 a[48:51], v163, s[4:7], s76 offen sc1
    v_cvt_pk_bf16_f32 v4, v8, v9
    v_cvt_pk_bf16_f32 v5, v10, v11
    v_cvt_pk_bf16_f32 v6, v12, v13
    v_cvt_pk_bf16_f32 v7, v14, v15
    v_and_b32 v140, v4, v212
    v_and_b32 v141, v5, v213
    v_and_b32 v142, v6, v214
    v_and_b32 v143, v7, v215
    v_xor_b32 v132, v4, v140
    v_xor_b32 v133, v5, v141
    v_xor_b32 v134, v6, v142
    v_xor_b32 v135, v7, v143
    s_waitcnt vmcnt(7)
    s_mov_b64 exec, 255
    buffer_store_dwordx4 v[252:255], v255, s[4:7], s94 offen sc1
    s_mov_b64 exec, -1
    s_barrier
    s_mov_b64 exec, 255
    buffer_store_dwordx4 v[252:255], v255, s[4:7], s92 offen sc1
    s_mov_b64 exec, -1
    v_exp_f32 v16, v16
    v_exp_f32 v17, v17
    s_waitcnt lgkmcnt(2)
    v_mfma_f32_32x32x16_bf16 v[144:159], v[172:175], v[128:131], v[144:159]
    ds_read_b64_tr_b16 v[180:181], v222 offset:0
    ds_read_b64_tr_b16 v[182:183], v223 offset:0
    v_exp_f32 v18, v18
    v_exp_f32 v19, v19
    v_exp_f32 v20, v20
    v_exp_f32 v21, v21
    s_waitcnt lgkmcnt(2)
    v_mfma_f32_32x32x16_bf16 v[144:159], v[176:179], v[140:143], v[144:159]
    ds_read_b64_tr_b16 v[168:169], v220 offset:5136
    ds_read_b64_tr_b16 v[170:171], v221 offset:5136
    v_exp_f32 v22, v22
    v_exp_f32 v23, v23
    s_mul_i32 s70, s16, 4096
    s_add_u32 m0, s70, 65536
    s_add_u32 s71, s70, s23
    buffer_load_dwordx4 v255, s[4:7], s71 offen offset:0 sc1 lds
    buffer_load_dwordx4 v255, s[4:7], s71 offen offset:1024 sc1 lds
    v_cvt_pk_bf16_f32 v16, v16, v17
    v_cvt_pk_bf16_f32 v17, v18, v19
    v_cvt_pk_bf16_f32 v18, v20, v21
    v_cvt_pk_bf16_f32 v19, v22, v23
    v_exp_f32 v24, v24
    v_exp_f32 v25, v25
    s_waitcnt lgkmcnt(2)
    v_mfma_f32_32x32x16_bf16 v[144:159], v[180:183], v[132:135], v[144:159]
    ds_read_b64_tr_b16 v[172:173], v222 offset:5136
    ds_read_b64_tr_b16 v[174:175], v223 offset:5136
    v_exp_f32 v26, v26
    v_exp_f32 v27, v27
    v_exp_f32 v28, v28
    v_exp_f32 v29, v29
    v_mfma_f32_32x32x16_bf16 v[48:63], a[252:255], v[200:203], v[48:63]
    v_exp_f32 v30, v30
    v_exp_f32 v31, v31
    buffer_load_dwordx4 v255, s[4:7], s71 offen offset:2048 sc1 lds
    buffer_load_dwordx4 v255, s[4:7], s71 offen offset:3072 sc1 lds
    v_cvt_pk_bf16_f32 v20, v24, v25
    v_cvt_pk_bf16_f32 v21, v26, v27
    v_cvt_pk_bf16_f32 v22, v28, v29
    v_cvt_pk_bf16_f32 v23, v30, v31
    v_exp_f32 v32, v32
    v_exp_f32 v33, v33
    s_waitcnt lgkmcnt(2)
    v_mfma_f32_32x32x16_bf16 v[144:159], v[168:171], v[16:19], v[144:159]
    ds_read_b64_tr_b16 v[176:177], v220 offset:10272
    ds_read_b64_tr_b16 v[178:179], v221 offset:10272
    v_exp_f32 v34, v34
    v_exp_f32 v35, v35
    v_exp_f32 v36, v36
    v_exp_f32 v37, v37
    s_waitcnt lgkmcnt(2)
    v_mfma_f32_32x32x16_bf16 v[144:159], v[172:175], v[20:23], v[144:159]
    ds_read_b64_tr_b16 v[180:181], v222 offset:10272
    ds_read_b64_tr_b16 v[182:183], v223 offset:10272
    v_exp_f32 v38, v38
    v_exp_f32 v39, v39
    s_add_u32 m0, s70, 81920
    s_add_u32 s71, s71, 16384
    buffer_load_dwordx4 v255, s[4:7], s71 offen offset:0 sc1 lds
    buffer_load_dwordx4 v255, s[4:7], s71 offen offset:1024 sc1 lds
    v_cvt_pk_bf16_f32 v32, v32, v33
    v_cvt_pk_bf16_f32 v33, v34, v35
    v_cvt_pk_bf16_f32 v34, v36, v37
    v_cvt_pk_bf16_f32 v35, v38, v39
    v_exp_f32 v40, v40
    v_exp_f32 v41, v41
    s_waitcnt lgkmcnt(2)
    v_mfma_f32_32x32x16_bf16 v[144:159], v[176:179], v[32:35], v[144:159]
    ds_read_b64_tr_b16 v[168:169], v220 offset:15408
    ds_read_b64_tr_b16 v[170:171], v221 offset:15408
    v_exp_f32 v42, v42
    v_exp_f32 v43, v43
    v_exp_f32 v44, v44
    v_exp_f32 v45, v45
    v_mfma_f32_32x32x16_bf16 v[64:79], a[252:255], v[200:203], v[64:79]
    v_exp_f32 v46, v46
    v_exp_f32 v47, v47
    buffer_load_dwordx4 v255, s[4:7], s71 offen offset:2048 sc1 lds
    buffer_load_dwordx4 v255, s[4:7], s71 offen offset:3072 sc1 lds
    v_cvt_pk_bf16_f32 v36, v40, v41
    v_cvt_pk_bf16_f32 v37, v42, v43
    v_cvt_pk_bf16_f32 v38, v44, v45
    v_cvt_pk_bf16_f32 v39, v46, v47
    v_exp_f32 v48, v48
    v_exp_f32 v49, v49
    s_waitcnt lgkmcnt(2)
    v_mfma_f32_32x32x16_bf16 v[144:159], v[180:183], v[36:39], v[144:159]
    ds_read_b64_tr_b16 v[172:173], v222 offset:15408
    ds_read_b64_tr_b16 v[174:175], v223 offset:15408
    v_exp_f32 v50, v50
    v_exp_f32 v51, v51
    v_exp_f32 v52, v52
    v_exp_f32 v53, v53
    v_exp_f32 v54, v54
    v_exp_f32 v55, v55
    s_add_u32 m0, s70, 98304
    s_add_u32 s71, s71, 16384
    buffer_load_dwordx4 v255, s[4:7], s71 offen offset:0 sc1 lds
    global_load_dword a250, v248, s[68:69]
    v_cvt_pk_bf16_f32 v48, v48, v49
    v_cvt_pk_bf16_f32 v49, v50, v51
    v_cvt_pk_bf16_f32 v50, v52, v53
    v_cvt_pk_bf16_f32 v51, v54, v55
    v_exp_f32 v56, v56
    v_exp_f32 v57, v57
    s_waitcnt lgkmcnt(2)
    v_mfma_f32_32x32x16_bf16 v[144:159], v[168:171], v[48:51], v[144:159]
    ds_read_b64_tr_b16 v[176:177], v220 offset:20544
    ds_read_b64_tr_b16 v[178:179], v221 offset:20544
    v_exp_f32 v58, v58
    v_exp_f32 v59, v59
    v_exp_f32 v60, v60
    v_exp_f32 v61, v61
    v_mfma_f32_32x32x16_bf16 v[80:95], a[252:255], v[200:203], v[80:95]
    v_exp_f32 v62, v62
    v_exp_f32 v63, v63
    buffer_load_dwordx4 v255, s[4:7], s71 offen offset:1024 sc1 lds
    buffer_load_dwordx4 v255, s[4:7], s71 offen offset:2048 sc1 lds
    v_cvt_pk_bf16_f32 v52, v56, v57
    v_cvt_pk_bf16_f32 v53, v58, v59
    v_cvt_pk_bf16_f32 v54, v60, v61
    v_cvt_pk_bf16_f32 v55, v62, v63
    v_exp_f32 v64, v64
    v_exp_f32 v65, v65
    s_waitcnt lgkmcnt(2)
    v_mfma_f32_32x32x16_bf16 v[144:159], v[172:175], v[52:55], v[144:159]
    ds_read_b64_tr_b16 v[180:181], v222 offset:20544
    ds_read_b64_tr_b16 v[182:183], v223 offset:20544
    v_exp_f32 v66, v66
    v_exp_f32 v67, v67
    v_exp_f32 v68, v68
    v_exp_f32 v69, v69
    v_exp_f32 v70, v70
    v_exp_f32 v71, v71
    buffer_load_dwordx4 v255, s[4:7], s71 offen offset:3072 sc1 lds
    s_add_u32 m0, s70, 114688
    s_add_u32 s71, s71, 16384
    buffer_load_dwordx4 v255, s[4:7], s71 offen offset:0 sc1 lds
    v_cvt_pk_bf16_f32 v64, v64, v65
    v_cvt_pk_bf16_f32 v65, v66, v67
    v_cvt_pk_bf16_f32 v66, v68, v69
    v_cvt_pk_bf16_f32 v67, v70, v71
    v_exp_f32 v72, v72
    v_exp_f32 v73, v73
    s_waitcnt lgkmcnt(2)
    v_mfma_f32_32x32x16_bf16 v[144:159], v[176:179], v[64:67], v[144:159]
    ds_read_b64_tr_b16 v[168:169], v220 offset:25680
    ds_read_b64_tr_b16 v[170:171], v221 offset:25680
    v_exp_f32 v74, v74
    v_exp_f32 v75, v75
    v_exp_f32 v76, v76
    v_exp_f32 v77, v77
    v_mfma_f32_32x32x16_bf16 v[96:111], a[252:255], v[200:203], v[96:111]
    v_exp_f32 v78, v78
    v_exp_f32 v79, v79
    buffer_load_dwordx4 v255, s[4:7], s71 offen offset:1024 sc1 lds
    buffer_load_dwordx4 v255, s[4:7], s71 offen offset:2048 sc1 lds
    v_cvt_pk_bf16_f32 v68, v72, v73
    v_cvt_pk_bf16_f32 v69, v74, v75
    v_cvt_pk_bf16_f32 v70, v76, v77
    v_cvt_pk_bf16_f32 v71, v78, v79
    v_exp_f32 v80, v80
    v_exp_f32 v81, v81
    s_waitcnt lgkmcnt(2)
    v_mfma_f32_32x32x16_bf16 v[144:159], v[180:183], v[68:71], v[144:159]
    ds_read_b64_tr_b16 v[172:173], v222 offset:25680
    ds_read_b64_tr_b16 v[174:175], v223 offset:25680
    v_exp_f32 v82, v82
    v_exp_f32 v83, v83
    v_exp_f32 v84, v84
    v_exp_f32 v85, v85
    v_exp_f32 v86, v86
    v_exp_f32 v87, v87
    buffer_load_dwordx4 v255, s[4:7], s71 offen offset:3072 sc1 lds
    s_add_u32 m0, s70, 131072
    s_add_u32 s71, s71, 16384
    buffer_load_dwordx4 v255, s[4:7], s71 offen offset:0 sc1 lds
    v_cvt_pk_bf16_f32 v80, v80, v81
    v_cvt_pk_bf16_f32 v81, v82, v83
    v_cvt_pk_bf16_f32 v82, v84, v85
    v_cvt_pk_bf16_f32 v83, v86, v87
    v_exp_f32 v88, v88
    v_exp_f32 v89, v89
    s_waitcnt lgkmcnt(2)
    v_mfma_f32_32x32x16_bf16 v[144:159], v[168:171], v[80:83], v[144:159]
    ds_read_b64_tr_b16 v[176:177], v220 offset:30816
    ds_read_b64_tr_b16 v[178:179], v221 offset:30816
    v_exp_f32 v90, v90
    v_exp_f32 v91, v91
    v_exp_f32 v92, v92
    v_exp_f32 v93, v93
    v_mfma_f32_32x32x16_bf16 v[112:127], a[252:255], v[200:203], v[112:127]
    v_exp_f32 v94, v94
    v_exp_f32 v95, v95
    buffer_load_dwordx4 v255, s[4:7], s71 offen offset:1024 sc1 lds
    buffer_load_dwordx4 v255, s[4:7], s71 offen offset:2048 sc1 lds
    v_cvt_pk_bf16_f32 v84, v88, v89
    v_cvt_pk_bf16_f32 v85, v90, v91
    v_cvt_pk_bf16_f32 v86, v92, v93
    v_cvt_pk_bf16_f32 v87, v94, v95
    s_add_u32 s25, s95, 30048256
    buffer_load_dword v251, v250, s[4:7], s25 offen sc1
    v_exp_f32 v96, v96
    v_exp_f32 v97, v97
    s_waitcnt lgkmcnt(2)
    v_mfma_f32_32x32x16_bf16 v[144:159], v[172:175], v[84:87], v[144:159]
    ds_read_b64_tr_b16 v[180:181], v222 offset:30816
    ds_read_b64_tr_b16 v[182:183], v223 offset:30816
    v_exp_f32 v98, v98
    v_exp_f32 v99, v99
    v_exp_f32 v100, v100
    v_exp_f32 v101, v101
    v_exp_f32 v102, v102
    v_exp_f32 v103, v103
    buffer_load_dwordx4 v255, s[4:7], s71 offen offset:3072 sc1 lds
    s_mul_i32 s70, s16, 2048
    s_add_u32 m0, s70, 147456
    s_add_u32 s71, s70, s23
    s_add_u32 s71, s71, 81920
    buffer_load_dwordx4 v255, s[4:7], s71 offen offset:0 sc1 lds
    v_cvt_pk_bf16_f32 v96, v96, v97
    v_cvt_pk_bf16_f32 v97, v98, v99
    v_cvt_pk_bf16_f32 v98, v100, v101
    v_cvt_pk_bf16_f32 v99, v102, v103
    v_exp_f32 v104, v104
    v_exp_f32 v105, v105
    s_waitcnt lgkmcnt(2)
    v_mfma_f32_32x32x16_bf16 v[144:159], v[176:179], v[96:99], v[144:159]
    ds_read_b64_tr_b16 v[168:169], v220 offset:35952
    ds_read_b64_tr_b16 v[170:171], v221 offset:35952
    v_exp_f32 v106, v106
    v_exp_f32 v107, v107
    v_exp_f32 v108, v108
    v_exp_f32 v109, v109
    v_exp_f32 v110, v110
    v_exp_f32 v111, v111
    buffer_load_dwordx4 v255, s[4:7], s71 offen offset:1024 sc1 lds
    v_cvt_pk_bf16_f32 v100, v104, v105
    v_cvt_pk_bf16_f32 v101, v106, v107
    v_cvt_pk_bf16_f32 v102, v108, v109
    v_cvt_pk_bf16_f32 v103, v110, v111
    s_mov_b32 s89, 31129600
    s_mov_b32 exec_lo, 0
    s_mov_b32 exec_hi, 0xfff
    buffer_load_dword v206, v219, s[4:7], s89 offen sc1
    s_mov_b64 exec, -1
    v_exp_f32 v112, v112
    v_exp_f32 v113, v113
    s_waitcnt lgkmcnt(2)
    v_mfma_f32_32x32x16_bf16 v[144:159], v[180:183], v[100:103], v[144:159]
    ds_read_b64_tr_b16 v[172:173], v222 offset:35952
    ds_read_b64_tr_b16 v[174:175], v223 offset:35952
    v_exp_f32 v114, v114
    v_exp_f32 v115, v115
    v_exp_f32 v116, v116
    v_exp_f32 v117, v117
    v_exp_f32 v118, v118
    v_exp_f32 v119, v119
    v_cvt_pk_bf16_f32 v112, v112, v113
    v_cvt_pk_bf16_f32 v113, v114, v115
    v_cvt_pk_bf16_f32 v114, v116, v117
    v_cvt_pk_bf16_f32 v115, v118, v119
    v_exp_f32 v120, v120
    v_exp_f32 v121, v121
    s_waitcnt lgkmcnt(2)
    v_mfma_f32_32x32x16_bf16 v[144:159], v[168:171], v[112:115], v[144:159]
    v_exp_f32 v122, v122
    v_exp_f32 v123, v123
    v_exp_f32 v124, v124
    v_exp_f32 v125, v125
    v_exp_f32 v126, v126
    v_exp_f32 v127, v127
    v_cvt_pk_bf16_f32 v116, v120, v121
    v_cvt_pk_bf16_f32 v117, v122, v123
    v_cvt_pk_bf16_f32 v118, v124, v125
    v_cvt_pk_bf16_f32 v119, v126, v127
    s_waitcnt lgkmcnt(0)
    s_nop 0
    v_mfma_f32_32x32x16_bf16 v[144:159], v[172:175], v[116:119], v[144:159]
    s_nop 11
    v_rcp_f32 v160, v156
    s_nop 0
    v_pk_mul_f32 v[144:145], v[144:145], v[160:161] op_sel_hi:[1,0]
    v_pk_mul_f32 v[146:147], v[146:147], v[160:161] op_sel_hi:[1,0]
    v_pk_mul_f32 v[148:149], v[148:149], v[160:161] op_sel_hi:[1,0]
    v_pk_mul_f32 v[150:151], v[150:151], v[160:161] op_sel_hi:[1,0]
    v_pk_mul_f32 v[152:153], v[152:153], v[160:161] op_sel_hi:[1,0]
    v_pk_mul_f32 v[154:155], v[154:155], v[160:161] op_sel_hi:[1,0]
    v_cvt_pk_bf16_f32 v164, v144, v145
    v_cvt_pk_bf16_f32 v165, v146, v147
    v_cvt_pk_bf16_f32 v166, v148, v149
    v_cvt_pk_bf16_f32 v167, v150, v151
    buffer_store_dwordx4 v[164:167], v255, s[4:7], s81 offen sc1
    v_cvt_pk_bf16_f32 v242, v152, v153
    v_cvt_pk_bf16_f32 v243, v154, v155
    s_mov_b32 exec_hi, 0
    buffer_store_dwordx4 v[240:243], v255, s[4:7], s82 offen sc1
    s_mov_b64 exec, -1
    s_add_u32 s25, s95, 30048256
    s_waitcnt vmcnt(6)
    v_cmp_ne_u32 vcc, s64, v251
    s_cbranch_vccz L_pdone_oa
    s_mov_b32 s65, 0x20000
L_poll_oa:
    buffer_load_dword v244, v250, s[4:7], s25 offen sc1
    s_waitcnt vmcnt(0)
    v_cmp_ne_u32 vcc, s64, v244
    s_cbranch_vccz L_pdone_oa
    s_sub_u32 s65, s65, 1
    s_cbranch_scc0 L_poll_oa
L_pdone_oa:
    buffer_load_dwordx4 a[100:103], v253, s[4:7], s96 offen offset:0 sc1
    buffer_load_dwordx4 a[104:107], v253, s[4:7], s96 offen offset:2048 sc1
    buffer_load_dwordx4 a[108:111], v253, s[4:7], s97 offen offset:0 sc1
    buffer_load_dwordx4 a[112:115], v253, s[4:7], s97 offen offset:2048 sc1
    buffer_load_dwordx4 a[116:119], v253, s[4:7], s98 offen offset:0 sc1
    buffer_load_dwordx4 a[120:123], v253, s[4:7], s98 offen offset:2048 sc1
    buffer_load_dwordx4 a[124:127], v253, s[4:7], s99 offen offset:0 sc1
    buffer_load_dwordx4 a[128:131], v253, s[4:7], s99 offen offset:2048 sc1
    v_accvgpr_read_b32 v0, a20
    v_accvgpr_read_b32 v160, a36
    v_accvgpr_read_b32 v1, a21
    v_accvgpr_read_b32 v161, a37
    v_accvgpr_read_b32 v2, a22
    v_accvgpr_read_b32 v162, a38
    v_accvgpr_read_b32 v3, a23
    v_accvgpr_read_b32 v163, a39
    v_accvgpr_read_b32 v4, a24
    v_accvgpr_read_b32 v164, a40
    v_accvgpr_read_b32 v5, a25
    v_accvgpr_read_b32 v165, a41
    v_accvgpr_read_b32 v6, a26
    v_accvgpr_read_b32 v166, a42
    v_accvgpr_read_b32 v7, a27
    v_accvgpr_read_b32 v167, a43
    v_accvgpr_read_b32 v8, a28
    v_accvgpr_read_b32 v168, a44
    v_accvgpr_read_b32 v9, a29
    v_accvgpr_read_b32 v169, a45
    v_accvgpr_read_b32 v10, a30
    v_accvgpr_read_b32 v170, a46
    v_accvgpr_read_b32 v11, a31
    v_accvgpr_read_b32 v171, a47
    v_accvgpr_read_b32 v12, a32
    v_accvgpr_read_b32 v172, a48
    v_accvgpr_read_b32 v13, a33
    v_accvgpr_read_b32 v173, a49
    v_accvgpr_read_b32 v14, a34
    v_accvgpr_read_b32 v174, a50
    v_accvgpr_read_b32 v15, a35
    v_accvgpr_read_b32 v175, a51
    v_cmp_le_u32 vcc, 40, v254
    v_min_u32 v16, 944, v255
    v_mov_b32 v18, 0
    v_cndmask_b32 v18, v18, 1.0, vcc
    v_and_b32 v180, 15, v254
    v_lshrrev_b32 v181, 5, v254
    v_lshl_add_u32 v180, v180, 1, v181
    v_bfe_u32 v181, v254, 4, 1
    s_mov_b32 s24, 0x04000c0c
    s_mov_b32 s26, 0x0706000c
    v_perm_b32 v3, v0, v1, s24
    v_perm_b32 v3, v3, v2, s26
    v_perm_b32 v7, v4, v5, s24
    v_perm_b32 v7, v7, v6, s26
    v_perm_b32 v11, v8, v9, s24
    v_perm_b32 v11, v11, v10, s26
    v_perm_b32 v15, v12, v13, s24
    v_perm_b32 v15, v15, v14, s26
    v_pk_add_f32 v[0:1], v[0:1], v[4:5]
    v_pk_add_f32 v[8:9], v[8:9], v[12:13]
    v_pk_add_f32 v[0:1], v[0:1], v[8:9]
    v_cvt_pk_bf16_f32 v17, v0, v1
    v_lshlrev_b32 v0, 16, v17
    v_and_b32 v1, 0xffff0000, v17
    v_pk_add_f32 v[0:1], v[0:1], v[18:19] op_sel_hi:[1,0]
    v_cvt_pk_bf16_f32 v17, v0, v1
    v_lshlrev_b32 v0, 16, v17
    v_and_b32 v1, 0xffff0000, v17
    v_pk_add_f32 v[2:3], v[2:3], v[6:7]
    v_pk_add_f32 v[10:11], v[10:11], v[14:15]
    v_pk_add_f32 v[2:3], v[2:3], v[10:11]
    v_cvt_pk_bf16_f32 v17, v2, v3
    v_lshlrev_b32 v2, 16, v17
    v_and_b32 v3, 0xffff0000, v17
    v_pk_add_f32 v[2:3], v[2:3], v[18:19] op_sel_hi:[1,0]
    v_cvt_pk_bf16_f32 v17, v2, v3
    v_lshlrev_b32 v2, 16, v17
    v_and_b32 v3, 0xffff0000, v17
    v_add_u32 v16, 161792, v16
    ds_write_b128 v16, v[0:3]
    s_waitcnt lgkmcnt(0)
    v_and_b32 v137, 48, v254
    v_lshlrev_b32 v136, 1, v137
    v_add_u32 v136, 161792, v136
    v_add_u32 v137, 161792, v137
    ds_read_b128 v[84:87], v136 offset:0
    ds_read_b128 v[88:91], v136 offset:16
    ds_read_b128 v[92:95], v136 offset:128
    ds_read_b128 v[96:99], v136 offset:144
    ds_read_b128 v[100:103], v137 offset:256
    v_and_b32 v139, 48, v254
    v_lshlrev_b32 v138, 1, v139
    v_add_u32 v138, 162432, v138
    v_add_u32 v139, 162432, v139
    ds_read_b128 v[140:143], v138 offset:0
    ds_read_b128 v[144:147], v138 offset:16
    ds_read_b128 v[148:151], v138 offset:128
    ds_read_b128 v[152:155], v138 offset:144
    ds_read_b128 v[156:159], v139 offset:256
    v_pk_add_f32 v[160:161], v[160:161], v[168:169]
    v_pk_add_f32 v[162:163], v[162:163], v[170:171]
    v_pk_add_f32 v[164:165], v[164:165], v[172:173]
    v_pk_add_f32 v[166:167], v[166:167], v[174:175]
    v_pk_add_f32 v[160:161], v[160:161], v[164:165]
    v_pk_add_f32 v[162:163], v[162:163], v[166:167]
    s_nop 1
    v_permlane32_swap_b32 v160, v162
    v_permlane32_swap_b32 v161, v163
    v_pk_add_f32 v[160:161], v[160:161], v[162:163]
    v_cvt_pk_bf16_f32 v162, v160, v160
    v_and_b32 v163, 0xffff0000, v162
    v_sub_f32 v160, v160, v163
    v_cvt_pk_bf16_f32 v163, v160, v160
    v_cvt_pk_bf16_f32 v164, v161, v161
    v_and_b32 v165, 0xffff0000, v164
    v_sub_f32 v161, v161, v165
    v_cvt_pk_bf16_f32 v165, v161, v161
    s_mov_b32 s26, 0xffff
    v_bfi_b32 v168, s26, v162, v163
    v_bfi_b32 v169, s26, v162, v164
    v_bfi_b32 v170, s26, v165, v164
    v_mov_b32 v171, 0
    v_mov_b32 v172, 0
    v_mov_b32 v173, 0
    v_mov_b32 v174, 0
    v_mov_b32 v175, 0
    s_min_u32 s24, s16, 2
    s_lshl_b32 s24, s24, 11
    s_add_u32 s24, s24, 155648
    v_lshlrev_b32 v182, 4, v180
    v_lshl_add_u32 v182, v181, 10, v182
    v_add_u32 v182, s24, v182
    ds_write_b128 v182, v[168:171]
    ds_write_b128 v182, v[172:175] offset:512
    s_add_u32 s24, s93, 30179328
    s_waitcnt vmcnt(8)
    s_mov_b64 exec, 255
    buffer_store_dwordx4 v[252:255], v255, s[4:7], s24 offen sc1
    s_mov_b64 exec, -1
    s_mov_b32 exec_lo, 0
    s_mov_b32 exec_hi, 0xfff
    v_cmp_ne_u32 vcc, s64, v206
    s_cbranch_vccz L_pdone_bg2
    s_mov_b32 s65, 0x20000
L_poll_bg2:
    buffer_load_dword v244, v219, s[4:7], s89 offen sc1
    s_waitcnt vmcnt(0)
    v_cmp_ne_u32 vcc, s64, v244
    s_cbranch_vccz L_pdone_bg2
    s_sub_u32 s65, s65, 1
    s_cbranch_scc0 L_poll_bg2
L_pdone_bg2:
    s_mov_b64 exec, -1
    buffer_load_dwordx4 v[160:163], v255, s[4:7], s74 offen offset:0 sc1
    buffer_load_dwordx4 v[164:167], v255, s[4:7], s74 offen offset:1024 sc1
    buffer_load_dwordx4 v[168:171], v255, s[4:7], s74 offen offset:2048 sc1
    buffer_load_dwordx4 v[172:175], v255, s[4:7], s74 offen offset:3072 sc1
    s_barrier
    s_waitcnt vmcnt(12)
    v_mfma_f32_16x16x32_bf16 v[0:3], a[160:163], a[100:103], 0
    s_lshl_b32 s24, s16, 11
    s_sub_u32 s24, 16384, s24
    v_mfma_f32_16x16x32_bf16 v[4:7], a[164:167], a[100:103], 0
    s_add_u32 s96, s96, 16384
    s_add_u32 s88, s96, s24
    v_mfma_f32_16x16x32_bf16 v[8:11], a[168:171], a[100:103], 0
    s_add_u32 s97, s97, 16384
    s_add_u32 s89, s97, s24
    v_mfma_f32_16x16x32_bf16 v[12:15], a[172:175], a[100:103], 0
    s_add_u32 s98, s98, 16384
    s_add_u32 s90, s98, s24
    v_mfma_f32_16x16x32_bf16 v[16:19], a[176:179], a[100:103], 0
    s_add_u32 s99, s99, 16384
    s_add_u32 s91, s99, s24
    s_waitcnt vmcnt(11)
    v_mfma_f32_16x16x32_bf16 v[0:3], a[180:183], a[104:107], v[0:3]
    s_add_u32 s68, s95, 30179328
    v_accvgpr_read_b32 v136, a240
    v_mfma_f32_16x16x32_bf16 v[4:7], a[184:187], a[104:107], v[4:7]
    v_lshlrev_b32 v104, 16, v136
    v_and_b32 v105, 0xffff0000, v136
    v_mfma_f32_16x16x32_bf16 v[8:11], a[188:191], a[104:107], v[8:11]
    v_accvgpr_read_b32 v136, a241
    v_lshlrev_b32 v106, 16, v136
    v_mfma_f32_16x16x32_bf16 v[12:15], a[192:195], a[104:107], v[12:15]
    v_and_b32 v107, 0xffff0000, v136
    v_accvgpr_read_b32 v136, a242
    v_mfma_f32_16x16x32_bf16 v[16:19], a[196:199], a[104:107], v[16:19]
    v_lshlrev_b32 v108, 16, v136
    v_and_b32 v109, 0xffff0000, v136
    s_waitcnt vmcnt(10)
    v_mfma_f32_16x16x32_bf16 v[20:23], a[160:163], a[108:111], 0
    v_accvgpr_read_b32 v136, a243
    v_lshlrev_b32 v110, 16, v136
    v_mfma_f32_16x16x32_bf16 v[24:27], a[164:167], a[108:111], 0
    v_and_b32 v111, 0xffff0000, v136
    v_accvgpr_read_b32 v136, a244
    v_mfma_f32_16x16x32_bf16 v[28:31], a[168:171], a[108:111], 0
    v_lshlrev_b32 v112, 16, v136
    v_and_b32 v113, 0xffff0000, v136
    v_mfma_f32_16x16x32_bf16 v[32:35], a[172:175], a[108:111], 0
    v_accvgpr_read_b32 v136, a245
    v_lshlrev_b32 v114, 16, v136
    v_mfma_f32_16x16x32_bf16 v[36:39], a[176:179], a[108:111], 0
    v_and_b32 v115, 0xffff0000, v136
    v_accvgpr_read_b32 v136, a246
    s_waitcnt vmcnt(9)
    v_mfma_f32_16x16x32_bf16 v[20:23], a[180:183], a[112:115], v[20:23]
    v_lshlrev_b32 v116, 16, v136
    v_and_b32 v117, 0xffff0000, v136
    v_mfma_f32_16x16x32_bf16 v[24:27], a[184:187], a[112:115], v[24:27]
    v_accvgpr_read_b32 v136, a247
    v_lshlrev_b32 v118, 16, v136
    v_mfma_f32_16x16x32_bf16 v[28:31], a[188:191], a[112:115], v[28:31]
    v_and_b32 v119, 0xffff0000, v136
    v_accvgpr_read_b32 v136, a248
    v_mfma_f32_16x16x32_bf16 v[32:35], a[192:195], a[112:115], v[32:35]
    v_lshlrev_b32 v120, 16, v136
    v_and_b32 v121, 0xffff0000, v136
    v_mfma_f32_16x16x32_bf16 v[36:39], a[196:199], a[112:115], v[36:39]
    v_accvgpr_read_b32 v136, a249
    v_lshlrev_b32 v122, 16, v136
    s_waitcnt vmcnt(8)
    v_mfma_f32_16x16x32_bf16 v[40:43], a[160:163], a[116:119], 0
    v_and_b32 v123, 0xffff0000, v136
    s_add_u32 s24, s16, 1
    v_mfma_f32_16x16x32_bf16 v[44:47], a[164:167], a[116:119], 0
    s_and_b32 s24, s24, 3
    s_mul_i32 s24, s24, 15360
    v_mfma_f32_16x16x32_bf16 v[48:51], a[168:171], a[116:119], 0
    v_add_u32 v80, s24, v255
    s_add_u32 s24, s16, 2
    v_mfma_f32_16x16x32_bf16 v[52:55], a[172:175], a[116:119], 0
    s_and_b32 s24, s24, 3
    s_mul_i32 s24, s24, 15360
    v_mfma_f32_16x16x32_bf16 v[56:59], a[176:179], a[116:119], 0
    v_add_u32 v81, s24, v255
    s_add_u32 s24, s16, 3
    s_waitcnt vmcnt(7)
    v_mfma_f32_16x16x32_bf16 v[40:43], a[180:183], a[120:123], v[40:43]
    s_and_b32 s24, s24, 3
    s_mul_i32 s24, s24, 15360
    v_mfma_f32_16x16x32_bf16 v[44:47], a[184:187], a[120:123], v[44:47]
    v_add_u32 v82, s24, v255
    s_add_u32 s24, s16, 4
    v_mfma_f32_16x16x32_bf16 v[48:51], a[188:191], a[120:123], v[48:51]
    s_and_b32 s24, s24, 3
    s_mul_i32 s24, s24, 15360
    v_mfma_f32_16x16x32_bf16 v[52:55], a[192:195], a[120:123], v[52:55]
    v_add_u32 v83, s24, v255
    s_lshr_b32 s24, s16, 1
    v_mfma_f32_16x16x32_bf16 v[56:59], a[196:199], a[120:123], v[56:59]
    s_add_u32 s24, s24, s22
    s_mul_i32 s24, s24, 40960
    s_waitcnt vmcnt(6)
    v_mfma_f32_16x16x32_bf16 v[60:63], a[160:163], a[124:127], 0
    s_mul_i32 s25, s20, 5120
    s_add_u32 s24, s24, s25
    v_mfma_f32_16x16x32_bf16 v[64:67], a[164:167], a[124:127], 0
    s_and_b32 s25, s16, 1
    s_lshl_b32 s25, s25, 8
    v_mfma_f32_16x16x32_bf16 v[68:71], a[168:171], a[124:127], 0
    s_add_u32 s24, s24, s25
    s_add_u32 s28, s24, 14974976
    v_mfma_f32_16x16x32_bf16 v[72:75], a[172:175], a[124:127], 0
    s_add_u32 s29, s28, 4096
    v_and_b32 v134, 15, v254
    v_mfma_f32_16x16x32_bf16 v[76:79], a[176:179], a[124:127], 0
    v_lshlrev_b32 v135, 3, v134
    v_lshlrev_b32 v134, 4, v134
    s_waitcnt vmcnt(5)
    v_mfma_f32_16x16x32_bf16 v[60:63], a[180:183], a[128:131], v[60:63]
    v_lshrrev_b32 v136, 5, v254
    v_lshl_add_u32 v134, v136, 9, v134
    v_mfma_f32_16x16x32_bf16 v[64:67], a[184:187], a[128:131], v[64:67]
    v_lshl_add_u32 v135, v136, 2, v135
    v_bfe_u32 v136, v254, 4, 1
    v_mfma_f32_16x16x32_bf16 v[68:71], a[188:191], a[128:131], v[68:71]
    v_lshl_add_u32 v134, v136, 3, v134
    s_lshl_b32 s66, s22, 1
    v_mfma_f32_16x16x32_bf16 v[72:75], a[192:195], a[128:131], v[72:75]
    s_add_u32 s66, s66, s16
    s_lshl_b32 s66, s66, 3
    v_mfma_f32_16x16x32_bf16 v[76:79], a[196:199], a[128:131], v[76:79]
    s_add_u32 s66, s66, s20
    s_lshl_b32 s67, s66, 7
    s_add_u32 s67, s67, 131072
    s_lshl_b32 s66, s66, 7
    s_add_u32 s66, s66, 30703616
    s_mov_b32 s65, 0x20000
L_poll_o:
    buffer_load_dword v244, v250, s[4:7], s68 offen sc1
    s_waitcnt vmcnt(0)
    v_cmp_ne_u32 vcc, s64, v244
    s_cbranch_vccz L_pdone_o
    s_sub_u32 s65, s65, 1
    s_cbranch_scc0 L_poll_o
L_pdone_o:
    buffer_load_dwordx4 a[132:135], v253, s[4:7], s96 offen offset:0 sc1
    buffer_load_dwordx4 a[136:139], v253, s[4:7], s96 offen offset:2048 sc1
    buffer_load_dwordx4 a[140:143], v253, s[4:7], s88 offen offset:0 sc1
    buffer_load_dwordx4 a[144:147], v253, s[4:7], s97 offen offset:0 sc1
    buffer_load_dwordx4 a[148:151], v253, s[4:7], s97 offen offset:2048 sc1
    buffer_load_dwordx4 a[152:155], v253, s[4:7], s89 offen offset:0 sc1
    buffer_load_dwordx4 a[156:159], v253, s[4:7], s98 offen offset:0 sc1
    buffer_load_dwordx4 a[72:75], v253, s[4:7], s98 offen offset:2048 sc1
    s_waitcnt vmcnt(7)
    v_mfma_f32_16x16x32_bf16 v[0:3], a[200:203], a[132:135], v[0:3]
    buffer_load_dwordx4 a[76:79], v253, s[4:7], s90 offen offset:0 sc1
    v_mfma_f32_16x16x32_bf16 v[4:7], a[204:207], a[132:135], v[4:7]
    v_mfma_f32_16x16x32_bf16 v[8:11], a[208:211], a[132:135], v[8:11]
    buffer_load_dwordx4 a[80:83], v253, s[4:7], s99 offen offset:0 sc1
    v_mfma_f32_16x16x32_bf16 v[12:15], a[212:215], a[132:135], v[12:15]
    v_mfma_f32_16x16x32_bf16 v[16:19], a[216:219], a[132:135], v[16:19]
    buffer_load_dwordx4 a[84:87], v253, s[4:7], s99 offen offset:2048 sc1
    s_waitcnt vmcnt(9)
    v_mfma_f32_16x16x32_bf16 v[0:3], a[220:223], a[136:139], v[0:3]
    v_mfma_f32_16x16x32_bf16 v[4:7], a[224:227], a[136:139], v[4:7]
    buffer_load_dwordx4 a[88:91], v253, s[4:7], s91 offen offset:0 sc1
    v_mfma_f32_16x16x32_bf16 v[8:11], a[228:231], a[136:139], v[8:11]
    v_mfma_f32_16x16x32_bf16 v[12:15], a[232:235], a[136:139], v[12:15]
    v_mfma_f32_16x16x32_bf16 v[16:19], a[236:239], a[136:139], v[16:19]
    s_add_u32 s74, s74, 4096
    buffer_load_dwordx4 v[176:179], v255, s[4:7], s74 offen offset:0 sc1
    s_waitcnt vmcnt(10)
    v_mfma_f32_16x16x32_bf16 v[0:3], a[0:3], a[140:143], v[0:3]
    v_mfma_f32_16x16x32_bf16 v[4:7], a[4:7], a[140:143], v[4:7]
    v_mfma_f32_16x16x32_bf16 v[8:11], a[8:11], a[140:143], v[8:11]
    buffer_load_dwordx4 v[180:183], v255, s[4:7], s74 offen offset:1024 sc1
    v_mfma_f32_16x16x32_bf16 v[12:15], a[12:15], a[140:143], v[12:15]
    v_mfma_f32_16x16x32_bf16 v[16:19], a[16:19], a[140:143], v[16:19]
    s_waitcnt vmcnt(10)
    v_mfma_f32_16x16x32_bf16 v[20:23], a[200:203], a[144:147], v[20:23]
    buffer_load_dwordx4 v[184:187], v255, s[4:7], s74 offen offset:2048 sc1
    v_mfma_f32_16x16x32_bf16 v[24:27], a[204:207], a[144:147], v[24:27]
    v_mfma_f32_16x16x32_bf16 v[28:31], a[208:211], a[144:147], v[28:31]
    v_mfma_f32_16x16x32_bf16 v[32:35], a[212:215], a[144:147], v[32:35]
    buffer_load_dwordx4 v[188:191], v255, s[4:7], s74 offen offset:3072 sc1
    ds_write_b128 v80, v[0:3] offset:0
    v_mfma_f32_16x16x32_bf16 v[36:39], a[216:219], a[144:147], v[36:39]
    ds_write_b128 v80, v[4:7] offset:1024
    s_waitcnt vmcnt(11)
    v_mfma_f32_16x16x32_bf16 v[20:23], a[220:223], a[148:151], v[20:23]
    ds_write_b128 v80, v[8:11] offset:2048
    v_mfma_f32_16x16x32_bf16 v[24:27], a[224:227], a[148:151], v[24:27]
    s_add_u32 s74, s74, 4096
    buffer_load_dwordx4 v[192:195], v255, s[4:7], s74 offen offset:0 sc1
    ds_write_b128 v80, v[12:15] offset:3072
    v_mfma_f32_16x16x32_bf16 v[28:31], a[228:231], a[148:151], v[28:31]
    ds_write_b128 v80, v[16:19] offset:4096
    v_mfma_f32_16x16x32_bf16 v[32:35], a[232:235], a[148:151], v[32:35]
    v_mfma_f32_16x16x32_bf16 v[36:39], a[236:239], a[148:151], v[36:39]
    buffer_load_dwordx4 v[196:199], v255, s[4:7], s74 offen offset:1024 sc1
    s_waitcnt vmcnt(12)
    v_mfma_f32_16x16x32_bf16 v[20:23], a[0:3], a[152:155], v[20:23]
    v_mfma_f32_16x16x32_bf16 v[24:27], a[4:7], a[152:155], v[24:27]
    v_mfma_f32_16x16x32_bf16 v[28:31], a[8:11], a[152:155], v[28:31]
    buffer_load_dwordx4 v[200:203], v255, s[4:7], s74 offen offset:2048 sc1
    v_mfma_f32_16x16x32_bf16 v[32:35], a[12:15], a[152:155], v[32:35]
    v_mfma_f32_16x16x32_bf16 v[36:39], a[16:19], a[152:155], v[36:39]
    s_waitcnt vmcnt(12)
    v_mfma_f32_16x16x32_bf16 v[40:43], a[200:203], a[156:159], v[40:43]
    buffer_load_dwordx4 v[204:207], v255, s[4:7], s74 offen offset:3072 sc1
    v_mfma_f32_16x16x32_bf16 v[44:47], a[204:207], a[156:159], v[44:47]
    v_mfma_f32_16x16x32_bf16 v[48:51], a[208:211], a[156:159], v[48:51]
    v_mfma_f32_16x16x32_bf16 v[52:55], a[212:215], a[156:159], v[52:55]
    s_add_u32 s74, s74, 4096
    buffer_load_dwordx4 v[208:211], v255, s[4:7], s74 offen offset:0 sc1
    ds_write_b128 v81, v[20:23] offset:5120
    v_mfma_f32_16x16x32_bf16 v[56:59], a[216:219], a[156:159], v[56:59]
    ds_write_b128 v81, v[24:27] offset:6144
    s_waitcnt vmcnt(13)
    v_mfma_f32_16x16x32_bf16 v[40:43], a[220:223], a[72:75], v[40:43]
    ds_write_b128 v81, v[28:31] offset:7168
    v_mfma_f32_16x16x32_bf16 v[44:47], a[224:227], a[72:75], v[44:47]
    buffer_load_dwordx4 v[212:215], v255, s[4:7], s74 offen offset:1024 sc1
    ds_write_b128 v81, v[32:35] offset:8192
    v_mfma_f32_16x16x32_bf16 v[48:51], a[228:231], a[72:75], v[48:51]
    ds_write_b128 v81, v[36:39] offset:9216
    v_mfma_f32_16x16x32_bf16 v[52:55], a[232:235], a[72:75], v[52:55]
    v_mfma_f32_16x16x32_bf16 v[56:59], a[236:239], a[72:75], v[56:59]
    buffer_load_dwordx4 v[216:219], v255, s[4:7], s74 offen offset:2048 sc1
    s_waitcnt vmcnt(14)
    v_mfma_f32_16x16x32_bf16 v[40:43], a[0:3], a[76:79], v[40:43]
    v_mfma_f32_16x16x32_bf16 v[44:47], a[4:7], a[76:79], v[44:47]
    v_mfma_f32_16x16x32_bf16 v[48:51], a[8:11], a[76:79], v[48:51]
    buffer_load_dwordx4 v[220:223], v255, s[4:7], s74 offen offset:3072 sc1
    v_mfma_f32_16x16x32_bf16 v[52:55], a[12:15], a[76:79], v[52:55]
    v_mfma_f32_16x16x32_bf16 v[56:59], a[16:19], a[76:79], v[56:59]
    s_waitcnt vmcnt(14)
    v_mfma_f32_16x16x32_bf16 v[60:63], a[200:203], a[80:83], v[60:63]
    s_add_u32 s74, s74, 4096
    buffer_load_dwordx4 v[224:227], v255, s[4:7], s74 offen offset:0 sc1
    v_mfma_f32_16x16x32_bf16 v[64:67], a[204:207], a[80:83], v[64:67]
    v_mfma_f32_16x16x32_bf16 v[68:71], a[208:211], a[80:83], v[68:71]
    v_mfma_f32_16x16x32_bf16 v[72:75], a[212:215], a[80:83], v[72:75]
    buffer_load_dwordx4 v[228:231], v255, s[4:7], s74 offen offset:1024 sc1
    ds_write_b128 v82, v[40:43] offset:10240
    v_mfma_f32_16x16x32_bf16 v[76:79], a[216:219], a[80:83], v[76:79]
    ds_write_b128 v82, v[44:47] offset:11264
    s_waitcnt vmcnt(15)
    v_mfma_f32_16x16x32_bf16 v[60:63], a[220:223], a[84:87], v[60:63]
    ds_write_b128 v82, v[48:51] offset:12288
    v_mfma_f32_16x16x32_bf16 v[64:67], a[224:227], a[84:87], v[64:67]
    buffer_load_dwordx4 v[232:235], v255, s[4:7], s74 offen offset:2048 sc1
    ds_write_b128 v82, v[52:55] offset:13312
    v_mfma_f32_16x16x32_bf16 v[68:71], a[228:231], a[84:87], v[68:71]
    ds_write_b128 v82, v[56:59] offset:14336
    s_waitcnt lgkmcnt(0)
    v_mfma_f32_16x16x32_bf16 v[72:75], a[232:235], a[84:87], v[72:75]
    s_barrier
    ds_read_b128 v[0:3], v83 offset:0
    v_mfma_f32_16x16x32_bf16 v[76:79], a[236:239], a[84:87], v[76:79]
    buffer_load_dwordx4 v[236:239], v255, s[4:7], s74 offen offset:3072 sc1
    ds_read_b128 v[4:7], v83 offset:1024
    ds_read_b128 v[8:11], v83 offset:2048
    s_waitcnt vmcnt(16)
    v_mfma_f32_16x16x32_bf16 v[60:63], a[0:3], a[88:91], v[60:63]
    ds_read_b128 v[12:15], v83 offset:3072
    ds_read_b128 v[16:19], v83 offset:4096
    v_mfma_f32_16x16x32_bf16 v[64:67], a[4:7], a[88:91], v[64:67]
    ds_read_b128 v[20:23], v83 offset:5120
    ds_read_b128 v[24:27], v83 offset:6144
    v_mfma_f32_16x16x32_bf16 v[68:71], a[8:11], a[88:91], v[68:71]
    s_add_u32 s74, s74, 4096
    buffer_load_dwordx4 v[240:243], v255, s[4:7], s74 offen offset:0 sc1
    ds_read_b128 v[28:31], v83 offset:7168
    ds_read_b128 v[32:35], v83 offset:8192
    v_mfma_f32_16x16x32_bf16 v[72:75], a[12:15], a[88:91], v[72:75]
    ds_read_b128 v[36:39], v83 offset:9216
    ds_read_b128 v[40:43], v83 offset:10240
    v_mfma_f32_16x16x32_bf16 v[76:79], a[16:19], a[88:91], v[76:79]
    ds_read_b128 v[44:47], v83 offset:11264
    ds_read_b128 v[48:51], v83 offset:12288
    ds_read_b128 v[52:55], v83 offset:13312
    ds_read_b128 v[56:59], v83 offset:14336
    s_waitcnt lgkmcnt(9)
    v_pk_add_f32 v[0:1], v[0:1], v[20:21]
    v_pk_add_f32 v[2:3], v[2:3], v[22:23]
    s_waitcnt lgkmcnt(8)
    v_pk_add_f32 v[4:5], v[4:5], v[24:25]
    v_pk_add_f32 v[6:7], v[6:7], v[26:27]
    s_waitcnt lgkmcnt(7)
    v_pk_add_f32 v[8:9], v[8:9], v[28:29]
    v_pk_add_f32 v[10:11], v[10:11], v[30:31]
    s_waitcnt lgkmcnt(6)
    v_pk_add_f32 v[12:13], v[12:13], v[32:33]
    v_pk_add_f32 v[14:15], v[14:15], v[34:35]
    s_waitcnt lgkmcnt(5)
    v_pk_add_f32 v[16:17], v[16:17], v[36:37]
    v_pk_add_f32 v[18:19], v[18:19], v[38:39]
    v_pk_add_f32 v[60:61], v[60:61], v[0:1]
    v_pk_add_f32 v[62:63], v[62:63], v[2:3]
    v_pk_add_f32 v[64:65], v[64:65], v[4:5]
    v_pk_add_f32 v[66:67], v[66:67], v[6:7]
    v_pk_add_f32 v[68:69], v[68:69], v[8:9]
    v_pk_add_f32 v[70:71], v[70:71], v[10:11]
    v_pk_add_f32 v[72:73], v[72:73], v[12:13]
    v_pk_add_f32 v[74:75], v[74:75], v[14:15]
    v_pk_add_f32 v[76:77], v[76:77], v[16:17]
    v_pk_add_f32 v[78:79], v[78:79], v[18:19]
    s_waitcnt lgkmcnt(4)
    v_pk_add_f32 v[60:61], v[60:61], v[40:41]
    v_pk_add_f32 v[62:63], v[62:63], v[42:43]
    s_waitcnt lgkmcnt(3)
    v_pk_add_f32 v[64:65], v[64:65], v[44:45]
    v_pk_add_f32 v[66:67], v[66:67], v[46:47]
    s_waitcnt lgkmcnt(2)
    v_pk_add_f32 v[68:69], v[68:69], v[48:49]
    v_pk_add_f32 v[70:71], v[70:71], v[50:51]
    s_waitcnt lgkmcnt(1)
    v_pk_add_f32 v[72:73], v[72:73], v[52:53]
    v_pk_add_f32 v[74:75], v[74:75], v[54:55]
    s_waitcnt lgkmcnt(0)
    v_pk_add_f32 v[76:77], v[76:77], v[56:57]
    v_pk_add_f32 v[78:79], v[78:79], v[58:59]
    v_pk_fma_f32 v[60:61], v[60:61], v[84:85], v[104:105]
    v_pk_mul_f32 v[140:141], v[60:61], v[140:141]
    v_cvt_pk_bf16_f32 v124, v140, v141
    v_pk_fma_f32 v[62:63], v[62:63], v[86:87], v[106:107]
    v_pk_mul_f32 v[142:143], v[62:63], v[142:143]
    v_cvt_pk_bf16_f32 v125, v142, v143
    v_pk_fma_f32 v[64:65], v[64:65], v[88:89], v[108:109]
    v_pk_mul_f32 v[144:145], v[64:65], v[144:145]
    v_cvt_pk_bf16_f32 v126, v144, v145
    v_pk_fma_f32 v[66:67], v[66:67], v[90:91], v[110:111]
    v_pk_mul_f32 v[146:147], v[66:67], v[146:147]
    v_cvt_pk_bf16_f32 v127, v146, v147
    buffer_store_dwordx4 v[124:127], v253, s[4:7], s28 offen sc1
    v_pk_fma_f32 v[68:69], v[68:69], v[92:93], v[112:113]
    v_pk_mul_f32 v[148:149], v[68:69], v[148:149]
    v_cvt_pk_bf16_f32 v128, v148, v149
    v_pk_fma_f32 v[70:71], v[70:71], v[94:95], v[114:115]
    v_pk_mul_f32 v[150:151], v[70:71], v[150:151]
    v_cvt_pk_bf16_f32 v129, v150, v151
    v_pk_fma_f32 v[72:73], v[72:73], v[96:97], v[116:117]
    v_pk_mul_f32 v[152:153], v[72:73], v[152:153]
    v_cvt_pk_bf16_f32 v130, v152, v153
    v_pk_fma_f32 v[74:75], v[74:75], v[98:99], v[118:119]
    v_pk_mul_f32 v[154:155], v[74:75], v[154:155]
    v_cvt_pk_bf16_f32 v131, v154, v155
    buffer_store_dwordx4 v[128:131], v253, s[4:7], s28 offen offset:2048 sc1
    v_pk_fma_f32 v[76:77], v[76:77], v[100:101], v[120:121]
    v_pk_mul_f32 v[156:157], v[76:77], v[156:157]
    v_cvt_pk_bf16_f32 v132, v156, v157
    v_pk_fma_f32 v[78:79], v[78:79], v[102:103], v[122:123]
    v_pk_mul_f32 v[158:159], v[78:79], v[158:159]
    v_cvt_pk_bf16_f32 v133, v158, v159
    v_mov_b32 v0, v132
    v_mov_b32 v1, v133
    v_mov_b32 v2, v132
    v_mov_b32 v3, v133
    s_mov_b32 exec_lo, -1
    v_permlane16_swap_b32 v0, v2
    v_permlane16_swap_b32 v1, v3
    s_mov_b32 exec_lo, 0xffff
    s_mov_b32 exec_hi, 0xffff
    buffer_store_dwordx4 v[0:3], v134, s[4:7], s29 offen sc1
    s_mov_b64 exec, -1
    v_pk_mul_f32 v[6:7], v[60:61], v[60:61]
    v_pk_add_f32 v[4:5], v[62:63], v[60:61]
    v_pk_fma_f32 v[6:7], v[62:63], v[62:63], v[6:7]
    v_pk_add_f32 v[4:5], v[64:65], v[4:5]
    v_pk_fma_f32 v[6:7], v[64:65], v[64:65], v[6:7]
    v_pk_add_f32 v[4:5], v[66:67], v[4:5]
    v_pk_fma_f32 v[6:7], v[66:67], v[66:67], v[6:7]
    v_pk_add_f32 v[4:5], v[68:69], v[4:5]
    v_pk_fma_f32 v[6:7], v[68:69], v[68:69], v[6:7]
    v_pk_add_f32 v[4:5], v[70:71], v[4:5]
    v_pk_fma_f32 v[6:7], v[70:71], v[70:71], v[6:7]
    v_pk_add_f32 v[4:5], v[72:73], v[4:5]
    v_pk_fma_f32 v[6:7], v[72:73], v[72:73], v[6:7]
    v_pk_add_f32 v[4:5], v[74:75], v[4:5]
    v_pk_fma_f32 v[6:7], v[74:75], v[74:75], v[6:7]
    v_pk_add_f32 v[4:5], v[76:77], v[4:5]
    v_pk_fma_f32 v[6:7], v[76:77], v[76:77], v[6:7]
    v_pk_add_f32 v[4:5], v[78:79], v[4:5]
    v_pk_fma_f32 v[6:7], v[78:79], v[78:79], v[6:7]
    v_add_f32 v4, v4, v5
    v_add_f32 v6, v6, v7
    s_nop 1
    v_permlane32_swap_b32 v4, v6
    v_add_f32 v4, v4, v6
    v_mov_b32 v5, v4
    s_nop 1
    v_permlane16_swap_b32 v4, v5
    v_add_f32 v4, v4, v5
    v_mov_b32 v5, v4
    s_nop 1
    v_permlane32_swap_b32 v4, v5
    s_mov_b64 exec, 0xffff
    buffer_store_dwordx2 v[4:5], v135, s[4:7], s67 offen sc1
    s_mov_b64 exec, -1
    v_cvt_pk_bf16_f32 v8, v60, v61
    v_accvgpr_write_b32 a240, v8
    v_cvt_pk_bf16_f32 v9, v62, v63
    v_accvgpr_write_b32 a241, v9
    v_cvt_pk_bf16_f32 v10, v64, v65
    v_accvgpr_write_b32 a242, v10
    v_cvt_pk_bf16_f32 v11, v66, v67
    v_accvgpr_write_b32 a243, v11
    v_cvt_pk_bf16_f32 v12, v68, v69
    v_accvgpr_write_b32 a244, v12
    v_cvt_pk_bf16_f32 v13, v70, v71
    v_accvgpr_write_b32 a245, v13
    v_cvt_pk_bf16_f32 v14, v72, v73
    v_accvgpr_write_b32 a246, v14
    v_cvt_pk_bf16_f32 v15, v74, v75
    v_accvgpr_write_b32 a247, v15
    v_cvt_pk_bf16_f32 v16, v76, v77
    v_accvgpr_write_b32 a248, v16
    v_cvt_pk_bf16_f32 v17, v78, v79
    v_accvgpr_write_b32 a249, v17
    s_barrier
    s_mul_i32 s70, s16, 4096
    s_add_u32 m0, s70, 0
    s_add_u32 s71, s70, s23
    s_add_u32 s71, s71, 90112
    buffer_load_dwordx4 v255, s[4:7], s71 offen offset:0 sc1 lds
    buffer_load_dwordx4 v255, s[4:7], s71 offen offset:1024 sc1 lds
    buffer_load_dwordx4 v255, s[4:7], s71 offen offset:2048 sc1 lds
    buffer_load_dwordx4 v255, s[4:7], s71 offen offset:3072 sc1 lds
    s_add_u32 m0, s70, 16384
    s_add_u32 s71, s71, 16384
    buffer_load_dwordx4 v255, s[4:7], s71 offen offset:0 sc1 lds
    buffer_load_dwordx4 v255, s[4:7], s71 offen offset:1024 sc1 lds
    buffer_load_dwordx4 v255, s[4:7], s71 offen offset:2048 sc1 lds
    buffer_load_dwordx4 v255, s[4:7], s71 offen offset:3072 sc1 lds
    s_waitcnt vmcnt(8)
    s_mov_b64 exec, 255
    buffer_store_dwordx4 v[252:255], v255, s[4:7], s66 offen sc1
    s_mov_b64 exec, -1
    s_add_u32 m0, s70, 32768
    s_add_u32 s71, s71, 16384
    buffer_load_dwordx4 v255, s[4:7], s71 offen offset:0 sc1 lds
    buffer_load_dwordx4 v255, s[4:7], s71 offen offset:1024 sc1 lds
    buffer_load_dwordx4 v255, s[4:7], s71 offen offset:2048 sc1 lds
    buffer_load_dwordx4 v255, s[4:7], s71 offen offset:3072 sc1 lds
    s_add_u32 m0, s70, 49152
    s_add_u32 s71, s71, 16384
    buffer_load_dwordx4 v255, s[4:7], s71 offen offset:0 sc1 lds
    buffer_load_dwordx4 v255, s[4:7], s71 offen offset:1024 sc1 lds
    buffer_load_dwordx4 v255, s[4:7], s71 offen offset:2048 sc1 lds
    buffer_load_dwordx4 v255, s[4:7], s71 offen offset:3072 sc1 lds
    buffer_load_dwordx4 a[160:163], v255, s[4:7], s74 offen offset:1024 sc1
    buffer_load_dwordx4 a[164:167], v255, s[4:7], s74 offen offset:2048 sc1
    buffer_load_dwordx4 a[168:171], v255, s[4:7], s74 offen offset:3072 sc1
    s_add_u32 s74, s74, 4096
    buffer_load_dwordx4 a[172:175], v255, s[4:7], s74 offen offset:0 sc1
    buffer_load_dwordx4 a[176:179], v255, s[4:7], s74 offen offset:1024 sc1
    v_add_u32 v106, 65536, v255
    v_add_u32 v107, 131072, v255
    s_lshl_b32 s69, s21, 11
    s_add_u32 s69, s69, 131072
    v_and_b32 v120, 15, v254
    v_lshlrev_b32 v128, 7, v120
    v_lshlrev_b32 v120, 3, v120
    v_bfe_u32 v121, v254, 4, 1
    v_lshl_add_u32 v120, v121, 10, v120
    v_lshrrev_b32 v121, 5, v254
    v_lshl_add_u32 v120, v121, 9, v120
    s_mul_i32 s28, s21, 98304
    s_mul_i32 s24, s18, 6144
    s_add_u32 s28, s28, s24
    s_add_u32 s28, s28, 21528576
    s_add_u32 s29, s28, 4096
    s_mul_i32 s26, s22, 98304
    s_mul_i32 s24, s16, 24576
    s_add_u32 s26, s26, s24
    s_add_u32 s26, s26, 21528576
    s_add_u32 s24, s16, 1
    s_bfe_u32 s27, s24, 0x10001
    s_mul_i32 s27, s27, 98304
    s_and_b32 s24, s24, 1
    s_lshl_b32 s24, s24, 8
    s_add_u32 s24, s24, s27
    s_add_u32 s96, s26, s24
    s_add_u32 s24, s16, 2
    s_bfe_u32 s27, s24, 0x10001
    s_mul_i32 s27, s27, 98304
    s_and_b32 s24, s24, 1
    s_lshl_b32 s24, s24, 8
    s_add_u32 s24, s24, s27
    s_add_u32 s97, s26, s24
    s_add_u32 s24, s16, 3
    s_bfe_u32 s27, s24, 0x10001
    s_mul_i32 s27, s27, 98304
    s_and_b32 s24, s24, 1
    s_lshl_b32 s24, s24, 8
    s_add_u32 s24, s24, s27
    s_add_u32 s98, s26, s24
    s_add_u32 s24, s16, 4
    s_bfe_u32 s27, s24, 0x10001
    s_mul_i32 s27, s27, 98304
    s_and_b32 s24, s24, 1
    s_lshl_b32 s24, s24, 8
    s_add_u32 s24, s24, s27
    s_add_u32 s99, s26, s24
    v_add_u32 v124, 0, v253
    v_add_u32 v125, 6144, v253
    v_add_u32 v126, 12288, v253
    v_add_u32 v127, 18432, v253
    s_mul_i32 s68, s21, 40960
    s_add_u32 s68, s68, 14974976
    s_or_b32 s24, s2, s16
    s_cmp_eq_u32 s24, 0
    s_cbranch_scc1 L_untag
L_untag_done:
    s_lshl_b32 s25, s21, 11
    s_add_u32 s25, s25, 30703616
    buffer_load_dword v244, v128, s[4:7], s25 offen sc1
    buffer_load_dwordx4 a[180:183], v255, s[4:7], s74 offen offset:2048 sc1
    buffer_load_dwordx4 a[184:187], v255, s[4:7], s74 offen offset:3072 sc1
    s_add_u32 s74, s74, 4096
    buffer_load_dwordx4 a[188:191], v255, s[4:7], s74 offen offset:0 sc1
    s_waitcnt vmcnt(3)
    v_cmp_ne_u32 vcc, s64, v244
    s_cbranch_vccz L_pdone_x1
    s_mov_b32 s65, 0x20000
L_poll_x1:
    buffer_load_dword v244, v128, s[4:7], s25 offen sc1
    s_waitcnt vmcnt(0)
    v_cmp_ne_u32 vcc, s64, v244
    s_cbranch_vccz L_pdone_x1
    s_sub_u32 s65, s65, 1
    s_cbranch_scc0 L_poll_x1
L_pdone_x1:
    buffer_load_dwordx4 a[0:3], v255, s[4:7], s68 offen offset:0 sc1
    buffer_load_dwordx4 a[4:7], v255, s[4:7], s68 offen offset:1024 sc1
    buffer_load_dwordx4 a[8:11], v255, s[4:7], s68 offen offset:2048 sc1
    buffer_load_dwordx4 a[12:15], v255, s[4:7], s68 offen offset:3072 sc1
    s_add_u32 s68, s68, 4096
    buffer_load_dwordx4 a[16:19], v255, s[4:7], s68 offen offset:0 sc1
    buffer_load_dwordx4 a[20:23], v255, s[4:7], s68 offen offset:1024 sc1
    buffer_load_dwordx4 a[24:27], v255, s[4:7], s68 offen offset:2048 sc1
    buffer_load_dwordx4 a[28:31], v255, s[4:7], s68 offen offset:3072 sc1
    ds_read_b128 v[64:67], v106 offset:0
    ds_read_b128 v[68:71], v106 offset:1024
    ds_read_b128 v[72:75], v106 offset:2048
    ds_read_b128 v[76:79], v106 offset:3072
    ds_read_b128 v[80:83], v106 offset:4096
    ds_read_b128 v[84:87], v106 offset:5120
    s_waitcnt vmcnt(7) lgkmcnt(4)
    v_mfma_f32_32x32x16_bf16 v[0:15], v[64:67], a[0:3], 0
    ds_read_b128 v[88:91], v106 offset:6144
    v_mfma_f32_32x32x16_bf16 v[16:31], v[68:71], a[0:3], 0
    ds_read_b128 v[92:95], v106 offset:7168
    s_add_u32 s68, s68, 4096
    buffer_load_dwordx4 a[32:35], v255, s[4:7], s68 offen offset:0 sc1
    s_waitcnt vmcnt(7) lgkmcnt(4)
    v_mfma_f32_32x32x16_bf16 v[0:15], v[72:75], a[4:7], v[0:15]
    ds_read_b128 v[64:67], v106 offset:8192
    v_mfma_f32_32x32x16_bf16 v[16:31], v[76:79], a[4:7], v[16:31]
    ds_read_b128 v[68:71], v106 offset:9216
    buffer_load_dwordx4 a[36:39], v255, s[4:7], s68 offen offset:1024 sc1
    s_waitcnt vmcnt(7) lgkmcnt(4)
    v_mfma_f32_32x32x16_bf16 v[0:15], v[80:83], a[8:11], v[0:15]
    ds_read_b128 v[72:75], v106 offset:10240
    v_mfma_f32_32x32x16_bf16 v[16:31], v[84:87], a[8:11], v[16:31]
    ds_read_b128 v[76:79], v106 offset:11264
    buffer_load_dwordx4 a[40:43], v255, s[4:7], s68 offen offset:2048 sc1
    s_waitcnt vmcnt(7) lgkmcnt(4)
    v_mfma_f32_32x32x16_bf16 v[0:15], v[88:91], a[12:15], v[0:15]
    ds_read_b128 v[80:83], v106 offset:12288
    v_mfma_f32_32x32x16_bf16 v[16:31], v[92:95], a[12:15], v[16:31]
    ds_read_b128 v[84:87], v106 offset:13312
    buffer_load_dwordx4 a[44:47], v255, s[4:7], s68 offen offset:3072 sc1
    s_waitcnt vmcnt(7) lgkmcnt(4)
    v_mfma_f32_32x32x16_bf16 v[0:15], v[64:67], a[16:19], v[0:15]
    ds_read_b128 v[88:91], v106 offset:14336
    v_mfma_f32_32x32x16_bf16 v[16:31], v[68:71], a[16:19], v[16:31]
    ds_read_b128 v[92:95], v106 offset:15360
    s_add_u32 s68, s68, 4096
    buffer_load_dwordx4 a[48:51], v255, s[4:7], s68 offen offset:0 sc1
    s_waitcnt vmcnt(7) lgkmcnt(4)
    v_mfma_f32_32x32x16_bf16 v[0:15], v[72:75], a[20:23], v[0:15]
    ds_read_b128 v[64:67], v106 offset:16384
    v_mfma_f32_32x32x16_bf16 v[16:31], v[76:79], a[20:23], v[16:31]
    ds_read_b128 v[68:71], v106 offset:17408
    buffer_load_dwordx4 a[52:55], v255, s[4:7], s68 offen offset:1024 sc1
    s_waitcnt vmcnt(7) lgkmcnt(4)
    v_mfma_f32_32x32x16_bf16 v[0:15], v[80:83], a[24:27], v[0:15]
    ds_read_b128 v[72:75], v106 offset:18432
    v_mfma_f32_32x32x16_bf16 v[16:31], v[84:87], a[24:27], v[16:31]
    ds_read_b128 v[76:79], v106 offset:19456
    buffer_load_dwordx4 a[56:59], v255, s[4:7], s68 offen offset:2048 sc1
    s_waitcnt vmcnt(7) lgkmcnt(4)
    v_mfma_f32_32x32x16_bf16 v[0:15], v[88:91], a[28:31], v[0:15]
    ds_read_b128 v[80:83], v106 offset:20480
    v_mfma_f32_32x32x16_bf16 v[16:31], v[92:95], a[28:31], v[16:31]
    ds_read_b128 v[84:87], v106 offset:21504
    buffer_load_dwordx4 a[60:63], v255, s[4:7], s68 offen offset:3072 sc1
    s_waitcnt vmcnt(7) lgkmcnt(4)
    v_mfma_f32_32x32x16_bf16 v[0:15], v[64:67], a[32:35], v[0:15]
    ds_read_b128 v[88:91], v106 offset:22528
    v_mfma_f32_32x32x16_bf16 v[16:31], v[68:71], a[32:35], v[16:31]
    ds_read_b128 v[92:95], v106 offset:23552
    s_add_u32 s68, s68, 4096
    buffer_load_dwordx4 a[64:67], v255, s[4:7], s68 offen offset:0 sc1
    s_waitcnt vmcnt(7) lgkmcnt(4)
    v_mfma_f32_32x32x16_bf16 v[0:15], v[72:75], a[36:39], v[0:15]
    ds_read_b128 v[64:67], v106 offset:24576
    v_mfma_f32_32x32x16_bf16 v[16:31], v[76:79], a[36:39], v[16:31]
    ds_read_b128 v[68:71], v106 offset:25600
    buffer_load_dwordx4 a[68:71], v255, s[4:7], s68 offen offset:1024 sc1
    s_waitcnt vmcnt(7) lgkmcnt(4)
    v_mfma_f32_32x32x16_bf16 v[0:15], v[80:83], a[40:43], v[0:15]
    ds_read_b128 v[72:75], v106 offset:26624
    v_mfma_f32_32x32x16_bf16 v[16:31], v[84:87], a[40:43], v[16:31]
    ds_read_b128 v[76:79], v106 offset:27648
    buffer_load_dwordx4 a[72:75], v255, s[4:7], s68 offen offset:2048 sc1
    s_waitcnt vmcnt(7) lgkmcnt(4)
    v_mfma_f32_32x32x16_bf16 v[0:15], v[88:91], a[44:47], v[0:15]
    ds_read_b128 v[80:83], v106 offset:28672
    v_mfma_f32_32x32x16_bf16 v[16:31], v[92:95], a[44:47], v[16:31]
    ds_read_b128 v[84:87], v106 offset:29696
    buffer_load_dwordx4 a[76:79], v255, s[4:7], s68 offen offset:3072 sc1
    s_waitcnt vmcnt(7) lgkmcnt(4)
    v_mfma_f32_32x32x16_bf16 v[0:15], v[64:67], a[48:51], v[0:15]
    ds_read_b128 v[88:91], v106 offset:30720
    v_mfma_f32_32x32x16_bf16 v[16:31], v[68:71], a[48:51], v[16:31]
    ds_read_b128 v[92:95], v106 offset:31744
    s_add_u32 s68, s68, 4096
    buffer_load_dwordx4 a[80:83], v255, s[4:7], s68 offen offset:0 sc1
    s_waitcnt vmcnt(7) lgkmcnt(4)
    v_mfma_f32_32x32x16_bf16 v[0:15], v[72:75], a[52:55], v[0:15]
    ds_read_b128 v[64:67], v106 offset:32768
    v_mfma_f32_32x32x16_bf16 v[16:31], v[76:79], a[52:55], v[16:31]
    ds_read_b128 v[68:71], v106 offset:33792
    buffer_load_dwordx2 v[108:109], v120, s[4:7], s69 offen offset:0 sc1
    buffer_load_dwordx2 v[110:111], v120, s[4:7], s69 offen offset:128 sc1
    buffer_load_dwordx2 v[112:113], v120, s[4:7], s69 offen offset:256 sc1
    buffer_load_dwordx2 v[114:115], v120, s[4:7], s69 offen offset:384 sc1
    buffer_load_dwordx4 a[84:87], v255, s[4:7], s68 offen offset:1024 sc1
    s_waitcnt vmcnt(11) lgkmcnt(4)
    v_mfma_f32_32x32x16_bf16 v[0:15], v[80:83], a[56:59], v[0:15]
    ds_read_b128 v[72:75], v106 offset:34816
    v_mfma_f32_32x32x16_bf16 v[16:31], v[84:87], a[56:59], v[16:31]
    ds_read_b128 v[76:79], v106 offset:35840
    buffer_load_dwordx4 a[88:91], v255, s[4:7], s68 offen offset:2048 sc1
    s_waitcnt vmcnt(11) lgkmcnt(4)
    v_mfma_f32_32x32x16_bf16 v[0:15], v[88:91], a[60:63], v[0:15]
    ds_read_b128 v[80:83], v106 offset:36864
    v_mfma_f32_32x32x16_bf16 v[16:31], v[92:95], a[60:63], v[16:31]
    ds_read_b128 v[84:87], v106 offset:37888
    buffer_load_dwordx4 a[92:95], v255, s[4:7], s68 offen offset:3072 sc1
    s_waitcnt vmcnt(11) lgkmcnt(4)
    v_mfma_f32_32x32x16_bf16 v[0:15], v[64:67], a[64:67], v[0:15]
    ds_read_b128 v[88:91], v106 offset:38912
    v_mfma_f32_32x32x16_bf16 v[16:31], v[68:71], a[64:67], v[16:31]
    ds_read_b128 v[92:95], v106 offset:39936
    s_add_u32 s68, s68, 4096
    buffer_load_dwordx4 a[96:99], v255, s[4:7], s68 offen offset:0 sc1
    s_waitcnt vmcnt(11) lgkmcnt(4)
    v_mfma_f32_32x32x16_bf16 v[0:15], v[72:75], a[68:71], v[0:15]
    ds_read_b128 v[64:67], v106 offset:40960
    v_mfma_f32_32x32x16_bf16 v[16:31], v[76:79], a[68:71], v[16:31]
    ds_read_b128 v[68:71], v106 offset:41984
    buffer_load_dwordx4 a[100:103], v255, s[4:7], s68 offen offset:1024 sc1
    s_waitcnt vmcnt(11) lgkmcnt(4)
    v_mfma_f32_32x32x16_bf16 v[0:15], v[80:83], a[72:75], v[0:15]
    ds_read_b128 v[72:75], v106 offset:43008
    v_mfma_f32_32x32x16_bf16 v[16:31], v[84:87], a[72:75], v[16:31]
    ds_read_b128 v[76:79], v106 offset:44032
    buffer_load_dwordx4 a[104:107], v255, s[4:7], s68 offen offset:2048 sc1
    s_waitcnt vmcnt(11) lgkmcnt(4)
    v_mfma_f32_32x32x16_bf16 v[0:15], v[88:91], a[76:79], v[0:15]
    ds_read_b128 v[80:83], v106 offset:45056
    v_mfma_f32_32x32x16_bf16 v[16:31], v[92:95], a[76:79], v[16:31]
    ds_read_b128 v[84:87], v106 offset:46080
    buffer_load_dwordx4 a[108:111], v255, s[4:7], s68 offen offset:3072 sc1
    s_waitcnt vmcnt(11) lgkmcnt(4)
    v_mfma_f32_32x32x16_bf16 v[0:15], v[64:67], a[80:83], v[0:15]
    ds_read_b128 v[88:91], v106 offset:47104
    v_mfma_f32_32x32x16_bf16 v[16:31], v[68:71], a[80:83], v[16:31]
    ds_read_b128 v[92:95], v106 offset:48128
    s_add_u32 s68, s68, 4096
    buffer_load_dwordx4 a[112:115], v255, s[4:7], s68 offen offset:0 sc1
    s_waitcnt vmcnt(7) lgkmcnt(4)
    v_mfma_f32_32x32x16_bf16 v[0:15], v[72:75], a[84:87], v[0:15]
    ds_read_b128 v[64:67], v106 offset:49152
    v_mfma_f32_32x32x16_bf16 v[16:31], v[76:79], a[84:87], v[16:31]
    ds_read_b128 v[68:71], v106 offset:50176
    buffer_load_dwordx4 a[116:119], v255, s[4:7], s68 offen offset:1024 sc1
    s_waitcnt vmcnt(7) lgkmcnt(4)
    v_mfma_f32_32x32x16_bf16 v[0:15], v[80:83], a[88:91], v[0:15]
    ds_read_b128 v[72:75], v106 offset:51200
    v_mfma_f32_32x32x16_bf16 v[16:31], v[84:87], a[88:91], v[16:31]
    ds_read_b128 v[76:79], v106 offset:52224
    buffer_load_dwordx4 a[120:123], v255, s[4:7], s68 offen offset:2048 sc1
    s_waitcnt vmcnt(7) lgkmcnt(4)
    v_mfma_f32_32x32x16_bf16 v[0:15], v[88:91], a[92:95], v[0:15]
    ds_read_b128 v[80:83], v106 offset:53248
    v_mfma_f32_32x32x16_bf16 v[16:31], v[92:95], a[92:95], v[16:31]
    ds_read_b128 v[84:87], v106 offset:54272
    buffer_load_dwordx4 a[124:127], v255, s[4:7], s68 offen offset:3072 sc1
    s_waitcnt vmcnt(7) lgkmcnt(4)
    v_mfma_f32_32x32x16_bf16 v[0:15], v[64:67], a[96:99], v[0:15]
    ds_read_b128 v[88:91], v106 offset:55296
    v_mfma_f32_32x32x16_bf16 v[16:31], v[68:71], a[96:99], v[16:31]
    ds_read_b128 v[92:95], v106 offset:56320
    s_add_u32 s68, s68, 4096
    buffer_load_dwordx4 a[128:131], v255, s[4:7], s68 offen offset:0 sc1
    s_waitcnt vmcnt(7) lgkmcnt(4)
    v_mfma_f32_32x32x16_bf16 v[0:15], v[72:75], a[100:103], v[0:15]
    ds_read_b128 v[64:67], v106 offset:57344
    v_mfma_f32_32x32x16_bf16 v[16:31], v[76:79], a[100:103], v[16:31]
    ds_read_b128 v[68:71], v106 offset:58368
    buffer_load_dwordx4 a[132:135], v255, s[4:7], s68 offen offset:1024 sc1
    s_waitcnt vmcnt(7) lgkmcnt(4)
    v_mfma_f32_32x32x16_bf16 v[0:15], v[80:83], a[104:107], v[0:15]
    ds_read_b128 v[72:75], v106 offset:59392
    v_mfma_f32_32x32x16_bf16 v[16:31], v[84:87], a[104:107], v[16:31]
    ds_read_b128 v[76:79], v106 offset:60416
    buffer_load_dwordx4 a[136:139], v255, s[4:7], s68 offen offset:2048 sc1
    s_waitcnt vmcnt(7) lgkmcnt(4)
    v_mfma_f32_32x32x16_bf16 v[0:15], v[88:91], a[108:111], v[0:15]
    ds_read_b128 v[80:83], v106 offset:61440
    v_mfma_f32_32x32x16_bf16 v[16:31], v[92:95], a[108:111], v[16:31]
    ds_read_b128 v[84:87], v106 offset:62464
    buffer_load_dwordx4 a[140:143], v255, s[4:7], s68 offen offset:3072 sc1
    s_waitcnt vmcnt(7) lgkmcnt(4)
    v_mfma_f32_32x32x16_bf16 v[0:15], v[64:67], a[112:115], v[0:15]
    ds_read_b128 v[88:91], v106 offset:63488
    v_add_f32 v116, v108, v110
    v_add_f32 v118, v112, v114
    v_add_f32 v116, v116, v118
    v_mov_b32 v118, v116
    s_nop 1
    v_permlane32_swap_b32 v116, v118
    v_mfma_f32_32x32x16_bf16 v[16:31], v[68:71], a[112:115], v[16:31]
    ds_read_b128 v[92:95], v106 offset:64512
    s_add_u32 s68, s68, 4096
    buffer_load_dwordx4 a[144:147], v255, s[4:7], s68 offen offset:0 sc1
    v_add_f32 v116, v116, v118
    v_add_f32 v117, v109, v111
    s_waitcnt vmcnt(7) lgkmcnt(4)
    v_mfma_f32_32x32x16_bf16 v[0:15], v[72:75], a[116:119], v[0:15]
    ds_read_b128 v[64:67], v107 offset:0
    v_add_f32 v118, v113, v115
    v_add_f32 v117, v117, v118
    v_mov_b32 v118, v117
    s_nop 1
    v_permlane32_swap_b32 v117, v118
    v_add_f32 v117, v117, v118
    v_mfma_f32_32x32x16_bf16 v[16:31], v[76:79], a[116:119], v[16:31]
    ds_read_b128 v[68:71], v107 offset:1024
    buffer_load_dwordx4 a[148:151], v255, s[4:7], s68 offen offset:1024 sc1
    v_mul_f32 v116, 0xbacccccd, v116
    v_mul_f32 v117, 0x3acccccd, v117
    v_fma_f32 v117, -v116, v116, v117
    s_waitcnt vmcnt(7) lgkmcnt(4)
    v_mfma_f32_32x32x16_bf16 v[0:15], v[80:83], a[120:123], v[0:15]
    ds_read_b128 v[72:75], v107 offset:2048
    v_max_f32 v117, 0, v117
    v_add_f32 v104, 0x3727c5ac, v117
    v_rsq_f32 v118, v104
    s_mov_b32 s26, 0xffff
    v_mul_f32 v117, v104, v118
    v_mfma_f32_32x32x16_bf16 v[16:31], v[84:87], a[120:123], v[16:31]
    ds_read_b128 v[76:79], v107 offset:3072
    buffer_load_dwordx4 a[152:155], v255, s[4:7], s68 offen offset:2048 sc1
    v_mul_f32 v100, 0xc0135761, v118
    v_mul_f32 v119, v118, v118
    v_mul_f32 v119, 0x3d372713, v119
    s_waitcnt vmcnt(7) lgkmcnt(4)
    v_mfma_f32_32x32x16_bf16 v[0:15], v[88:91], a[124:127], v[0:15]
    ds_read_b128 v[80:83], v107 offset:4096
    v_mul_f32 v102, v100, v119
    v_cvt_pk_bf16_f32 v96, v116, v116
    v_and_b32 v109, 0xffff0000, v96
    v_sub_f32 v116, v116, v109
    v_cvt_pk_bf16_f32 v109, v116, v116
    v_mfma_f32_32x32x16_bf16 v[16:31], v[92:95], a[124:127], v[16:31]
    ds_read_b128 v[84:87], v107 offset:5120
    buffer_load_dwordx4 a[156:159], v255, s[4:7], s68 offen offset:3072 sc1
    v_cvt_pk_bf16_f32 v110, v117, v117
    v_and_b32 v111, 0xffff0000, v110
    v_sub_f32 v117, v117, v111
    s_barrier
    s_waitcnt vmcnt(7) lgkmcnt(4)
    v_mfma_f32_32x32x16_bf16 v[0:15], v[64:67], a[128:131], v[0:15]
    ds_read_b128 v[88:91], v107 offset:6144
    s_mul_i32 s70, s16, 4096
    s_add_u32 m0, s70, 65536
    s_add_u32 s71, s70, s23
    s_add_u32 s71, s71, 155648
    buffer_load_dwordx4 v255, s[4:7], s71 offen offset:0 sc1 lds
    v_mfma_f32_32x32x16_bf16 v[16:31], v[68:71], a[128:131], v[16:31]
    ds_read_b128 v[92:95], v107 offset:7168
    v_cvt_pk_bf16_f32 v111, v117, v117
    v_bfi_b32 v97, s26, v109, v110
    v_bfi_b32 v98, s26, v110, v111
    v_mov_b32 v99, 0
    s_waitcnt vmcnt(7) lgkmcnt(4)
    v_mfma_f32_32x32x16_bf16 v[0:15], v[72:75], a[132:135], v[0:15]
    ds_read_b128 v[64:67], v107 offset:8192
    v_mfma_f32_32x32x16_bf16 v[16:31], v[76:79], a[132:135], v[16:31]
    ds_read_b128 v[68:71], v107 offset:9216
    buffer_load_dwordx4 v255, s[4:7], s71 offen offset:1024 sc1 lds
    s_waitcnt vmcnt(7) lgkmcnt(4)
    v_mfma_f32_32x32x16_bf16 v[0:15], v[80:83], a[136:139], v[0:15]
    ds_read_b128 v[72:75], v107 offset:10240
    v_mfma_f32_32x32x16_bf16 v[16:31], v[84:87], a[136:139], v[16:31]
    ds_read_b128 v[76:79], v107 offset:11264
    s_waitcnt vmcnt(6) lgkmcnt(4)
    v_mfma_f32_32x32x16_bf16 v[0:15], v[88:91], a[140:143], v[0:15]
    ds_read_b128 v[80:83], v107 offset:12288
    buffer_load_dwordx4 v255, s[4:7], s71 offen offset:2048 sc1 lds
    v_mfma_f32_32x32x16_bf16 v[16:31], v[92:95], a[140:143], v[16:31]
    ds_read_b128 v[84:87], v107 offset:13312
    s_waitcnt vmcnt(6) lgkmcnt(4)
    v_mfma_f32_32x32x16_bf16 v[0:15], v[64:67], a[144:147], v[0:15]
    ds_read_b128 v[88:91], v107 offset:14336
    v_mfma_f32_32x32x16_bf16 v[16:31], v[68:71], a[144:147], v[16:31]
    ds_read_b128 v[92:95], v107 offset:15360
    buffer_load_dwordx4 v255, s[4:7], s71 offen offset:3072 sc1 lds
    s_waitcnt vmcnt(6) lgkmcnt(4)
    v_mfma_f32_32x32x16_bf16 v[0:15], v[72:75], a[148:151], v[0:15]
    ds_read_b128 v[64:67], v107 offset:24576
    v_mfma_f32_32x32x16_bf16 v[16:31], v[76:79], a[148:151], v[16:31]
    ds_read_b128 v[68:71], v107 offset:25600
    s_waitcnt vmcnt(5) lgkmcnt(4)
    v_mfma_f32_32x32x16_bf16 v[0:15], v[80:83], a[152:155], v[0:15]
    ds_read_b128 v[72:75], v107 offset:16384
    s_add_u32 m0, s70, 81920
    s_add_u32 s71, s71, 16384
    buffer_load_dwordx4 v255, s[4:7], s71 offen offset:0 sc1 lds
    v_mfma_f32_32x32x16_bf16 v[16:31], v[84:87], a[152:155], v[16:31]
    ds_read_b128 v[76:79], v107 offset:17408
    s_waitcnt vmcnt(5) lgkmcnt(4)
    v_mfma_f32_32x32x16_bf16 v[0:15], v[88:91], a[156:159], v[0:15]
    ds_read_b128 v[80:83], v107 offset:18432
    v_mfma_f32_32x32x16_bf16 v[16:31], v[92:95], a[156:159], v[16:31]
    ds_read_b128 v[84:87], v107 offset:19456
    buffer_load_dwordx4 v255, s[4:7], s71 offen offset:1024 sc1 lds
    s_waitcnt lgkmcnt(4)
    v_mfma_f32_32x32x16_bf16 v[0:15], v[64:67], v[96:99], v[0:15]
    ds_read_b128 v[88:91], v107 offset:20480
    v_mfma_f32_32x32x16_bf16 v[16:31], v[68:71], v[96:99], v[16:31]
    ds_read_b128 v[92:95], v107 offset:21504
    s_waitcnt lgkmcnt(4)
    v_mfma_f32_32x32x16_bf16 v[32:47], v[72:75], a[0:3], 0
    ds_read_b128 v[64:67], v107 offset:22528
    buffer_load_dwordx4 v255, s[4:7], s71 offen offset:2048 sc1 lds
    v_mfma_f32_32x32x16_bf16 v[48:63], v[76:79], a[0:3], 0
    ds_read_b128 v[68:71], v107 offset:23552
    s_waitcnt lgkmcnt(4)
    v_mfma_f32_32x32x16_bf16 v[32:47], v[80:83], a[4:7], v[32:47]
    ds_read_b128 v[72:75], v255 offset:0
    v_mul_f32 v108, v0, v0
    v_fma_f32 v108, v108, v102, v100
    v_mul_f32 v108, v108, v0
    v_exp_f32 v108, v108
    v_mfma_f32_32x32x16_bf16 v[48:63], v[84:87], a[4:7], v[48:63]
    ds_read_b128 v[76:79], v255 offset:1024
    buffer_load_dwordx4 v255, s[4:7], s71 offen offset:3072 sc1 lds
    v_mul_f32 v16, v0, v16
    v_fma_f32 v108, v108, v104, v104
    s_waitcnt lgkmcnt(4)
    v_mfma_f32_32x32x16_bf16 v[32:47], v[88:91], a[8:11], v[32:47]
    ds_read_b128 v[80:83], v255 offset:2048
    v_rcp_f32 v108, v108
    v_mul_f32 v109, v1, v1
    v_fma_f32 v109, v109, v102, v100
    v_mul_f32 v109, v109, v1
    v_mfma_f32_32x32x16_bf16 v[48:63], v[92:95], a[8:11], v[48:63]
    ds_read_b128 v[84:87], v255 offset:3072
    v_exp_f32 v109, v109
    v_mul_f32 v17, v1, v17
    v_fma_f32 v109, v109, v104, v104
    s_waitcnt lgkmcnt(4)
    v_mfma_f32_32x32x16_bf16 v[32:47], v[64:67], a[12:15], v[32:47]
    ds_read_b128 v[88:91], v255 offset:4096
    s_add_u32 m0, s70, 98304
    s_add_u32 s71, s71, 16384
    buffer_load_dwordx4 v255, s[4:7], s71 offen offset:0 sc1 lds
    v_rcp_f32 v109, v109
    v_mfma_f32_32x32x16_bf16 v[48:63], v[68:71], a[12:15], v[48:63]
    ds_read_b128 v[92:95], v255 offset:5120
    v_mul_f32 v16, v16, v108
    v_mul_f32 v17, v17, v109
    v_cvt_pk_bf16_f32 v116, v16, v17
    v_mul_f32 v110, v2, v2
    s_waitcnt lgkmcnt(4)
    v_mfma_f32_32x32x16_bf16 v[32:47], v[72:75], a[16:19], v[32:47]
    ds_read_b128 v[64:67], v255 offset:6144
    v_fma_f32 v110, v110, v102, v100
    v_mul_f32 v110, v110, v2
    v_exp_f32 v110, v110
    v_mul_f32 v18, v2, v18
    v_mfma_f32_32x32x16_bf16 v[48:63], v[76:79], a[16:19], v[48:63]
    ds_read_b128 v[68:71], v255 offset:7168
    buffer_load_dwordx4 v255, s[4:7], s71 offen offset:1024 sc1 lds
    v_fma_f32 v110, v110, v104, v104
    v_rcp_f32 v110, v110
    s_barrier
    s_waitcnt lgkmcnt(4)
    v_mfma_f32_32x32x16_bf16 v[32:47], v[80:83], a[20:23], v[32:47]
    ds_read_b128 v[72:75], v255 offset:8192
    v_mul_f32 v111, v3, v3
    v_fma_f32 v111, v111, v102, v100
    v_mul_f32 v111, v111, v3
    v_exp_f32 v111, v111
    v_mfma_f32_32x32x16_bf16 v[48:63], v[84:87], a[20:23], v[48:63]
    ds_read_b128 v[76:79], v255 offset:9216
    v_mul_f32 v19, v3, v19
    v_fma_f32 v111, v111, v104, v104
    v_rcp_f32 v111, v111
    s_waitcnt lgkmcnt(4)
    v_mfma_f32_32x32x16_bf16 v[32:47], v[88:91], a[24:27], v[32:47]
    ds_read_b128 v[80:83], v255 offset:10240
    buffer_load_dwordx4 v255, s[4:7], s71 offen offset:2048 sc1 lds
    v_mul_f32 v18, v18, v110
    v_mul_f32 v19, v19, v111
    v_cvt_pk_bf16_f32 v117, v18, v19
    v_mul_f32 v112, v4, v4
    v_mfma_f32_32x32x16_bf16 v[48:63], v[92:95], a[24:27], v[48:63]
    ds_read_b128 v[84:87], v255 offset:11264
    v_fma_f32 v112, v112, v102, v100
    v_mul_f32 v112, v112, v4
    v_exp_f32 v112, v112
    s_waitcnt lgkmcnt(4)
    v_mfma_f32_32x32x16_bf16 v[32:47], v[64:67], a[28:31], v[32:47]
    ds_read_b128 v[88:91], v255 offset:12288
    v_mul_f32 v20, v4, v20
    v_fma_f32 v112, v112, v104, v104
    v_rcp_f32 v112, v112
    v_mul_f32 v113, v5, v5
    v_mfma_f32_32x32x16_bf16 v[48:63], v[68:71], a[28:31], v[48:63]
    ds_read_b128 v[92:95], v255 offset:13312
    buffer_load_dwordx4 v255, s[4:7], s71 offen offset:3072 sc1 lds
    v_fma_f32 v113, v113, v102, v100
    v_mul_f32 v113, v113, v5
    s_waitcnt lgkmcnt(4)
    v_mfma_f32_32x32x16_bf16 v[32:47], v[72:75], a[32:35], v[32:47]
    ds_read_b128 v[64:67], v255 offset:14336
    v_exp_f32 v113, v113
    v_mul_f32 v21, v5, v21
    v_fma_f32 v113, v113, v104, v104
    v_mfma_f32_32x32x16_bf16 v[48:63], v[76:79], a[32:35], v[48:63]
    ds_read_b128 v[68:71], v255 offset:15360
    v_rcp_f32 v113, v113
    v_mul_f32 v20, v20, v112
    v_mul_f32 v21, v21, v113
    s_waitcnt lgkmcnt(4)
    v_mfma_f32_32x32x16_bf16 v[32:47], v[80:83], a[36:39], v[32:47]
    ds_read_b128 v[72:75], v255 offset:16384
    s_add_u32 m0, s70, 114688
    s_add_u32 s71, s71, 16384
    buffer_load_dwordx4 v255, s[4:7], s71 offen offset:0 sc1 lds
    v_cvt_pk_bf16_f32 v118, v20, v21
    v_mul_f32 v114, v6, v6
    v_mfma_f32_32x32x16_bf16 v[48:63], v[84:87], a[36:39], v[48:63]
    ds_read_b128 v[76:79], v255 offset:17408
    v_fma_f32 v114, v114, v102, v100
    v_mul_f32 v114, v114, v6
    v_exp_f32 v114, v114
    s_waitcnt lgkmcnt(4)
    v_mfma_f32_32x32x16_bf16 v[32:47], v[88:91], a[40:43], v[32:47]
    ds_read_b128 v[80:83], v255 offset:18432
    v_mul_f32 v22, v6, v22
    v_fma_f32 v114, v114, v104, v104
    v_rcp_f32 v114, v114
    v_mul_f32 v115, v7, v7
    v_mfma_f32_32x32x16_bf16 v[48:63], v[92:95], a[40:43], v[48:63]
    ds_read_b128 v[84:87], v255 offset:19456
    buffer_load_dwordx4 v255, s[4:7], s71 offen offset:1024 sc1 lds
    v_fma_f32 v115, v115, v102, v100
    v_mul_f32 v115, v115, v7
    s_waitcnt lgkmcnt(4)
    v_mfma_f32_32x32x16_bf16 v[32:47], v[64:67], a[44:47], v[32:47]
    ds_read_b128 v[88:91], v255 offset:20480
    v_exp_f32 v115, v115
    v_mul_f32 v23, v7, v23
    v_fma_f32 v115, v115, v104, v104
    v_mfma_f32_32x32x16_bf16 v[48:63], v[68:71], a[44:47], v[48:63]
    ds_read_b128 v[92:95], v255 offset:21504
    v_rcp_f32 v115, v115
    v_mul_f32 v22, v22, v114
    v_mul_f32 v23, v23, v115
    s_waitcnt lgkmcnt(4)
    v_mfma_f32_32x32x16_bf16 v[32:47], v[72:75], a[48:51], v[32:47]
    ds_read_b128 v[64:67], v255 offset:22528
    buffer_load_dwordx4 v255, s[4:7], s71 offen offset:2048 sc1 lds
    v_cvt_pk_bf16_f32 v119, v22, v23
    buffer_store_dwordx4 v[116:119], v255, s[4:7], s28 offen offset:0 sc1
    v_mul_f32 v108, v8, v8
    v_fma_f32 v108, v108, v102, v100
    v_mfma_f32_32x32x16_bf16 v[48:63], v[76:79], a[48:51], v[48:63]
    ds_read_b128 v[68:71], v255 offset:23552
    v_mul_f32 v108, v108, v8
    v_exp_f32 v108, v108
    v_mul_f32 v24, v8, v24
    s_waitcnt lgkmcnt(4)
    v_mfma_f32_32x32x16_bf16 v[32:47], v[80:83], a[52:55], v[32:47]
    ds_read_b128 v[72:75], v255 offset:24576
    v_fma_f32 v108, v108, v104, v104
    v_rcp_f32 v108, v108
    v_mul_f32 v109, v9, v9
    v_fma_f32 v109, v109, v102, v100
    v_mfma_f32_32x32x16_bf16 v[48:63], v[84:87], a[52:55], v[48:63]
    ds_read_b128 v[76:79], v255 offset:25600
    buffer_load_dwordx4 v255, s[4:7], s71 offen offset:3072 sc1 lds
    v_mul_f32 v109, v109, v9
    v_exp_f32 v109, v109
    s_waitcnt lgkmcnt(4)
    v_mfma_f32_32x32x16_bf16 v[32:47], v[88:91], a[56:59], v[32:47]
    ds_read_b128 v[80:83], v255 offset:26624
    v_mul_f32 v25, v9, v25
    v_fma_f32 v109, v109, v104, v104
    v_rcp_f32 v109, v109
    v_mul_f32 v24, v24, v108
    v_mfma_f32_32x32x16_bf16 v[48:63], v[92:95], a[56:59], v[48:63]
    ds_read_b128 v[84:87], v255 offset:27648
    v_mul_f32 v25, v25, v109
    v_cvt_pk_bf16_f32 v120, v24, v25
    v_mul_f32 v110, v10, v10
    v_fma_f32 v110, v110, v102, v100
    s_waitcnt lgkmcnt(4)
    v_mfma_f32_32x32x16_bf16 v[32:47], v[64:67], a[60:63], v[32:47]
    ds_read_b128 v[88:91], v255 offset:28672
    s_mul_i32 s70, s16, 4096
    s_add_u32 m0, s70, 131072
    s_add_u32 s71, s70, s23
    s_add_u32 s71, s71, 221184
    buffer_load_dwordx4 v255, s[4:7], s71 offen offset:0 sc1 lds
    v_mfma_f32_32x32x16_bf16 v[48:63], v[68:71], a[60:63], v[48:63]
    ds_read_b128 v[92:95], v255 offset:29696
    v_mul_f32 v110, v110, v10
    v_exp_f32 v110, v110
    v_mul_f32 v26, v10, v26
    s_waitcnt lgkmcnt(4)
    v_mfma_f32_32x32x16_bf16 v[32:47], v[72:75], a[64:67], v[32:47]
    ds_read_b128 v[64:67], v255 offset:30720
    v_fma_f32 v110, v110, v104, v104
    v_rcp_f32 v110, v110
    v_mul_f32 v111, v11, v11
    v_fma_f32 v111, v111, v102, v100
    v_mfma_f32_32x32x16_bf16 v[48:63], v[76:79], a[64:67], v[48:63]
    ds_read_b128 v[68:71], v255 offset:31744
    buffer_load_dwordx4 v255, s[4:7], s71 offen offset:1024 sc1 lds
    v_mul_f32 v111, v111, v11
    v_exp_f32 v111, v111
    s_waitcnt lgkmcnt(4)
    v_mfma_f32_32x32x16_bf16 v[32:47], v[80:83], a[68:71], v[32:47]
    ds_read_b128 v[72:75], v255 offset:32768
    v_mul_f32 v27, v11, v27
    v_fma_f32 v111, v111, v104, v104
    v_rcp_f32 v111, v111
    v_mul_f32 v26, v26, v110
    v_mfma_f32_32x32x16_bf16 v[48:63], v[84:87], a[68:71], v[48:63]
    ds_read_b128 v[76:79], v255 offset:33792
    v_mul_f32 v27, v27, v111
    v_cvt_pk_bf16_f32 v121, v26, v27
    v_mul_f32 v112, v12, v12
    v_fma_f32 v112, v112, v102, v100
    s_waitcnt lgkmcnt(4)
    v_mfma_f32_32x32x16_bf16 v[32:47], v[88:91], a[72:75], v[32:47]
    ds_read_b128 v[80:83], v255 offset:34816
    buffer_load_dwordx4 v255, s[4:7], s71 offen offset:2048 sc1 lds
    v_mul_f32 v112, v112, v12
    v_exp_f32 v112, v112
    v_mul_f32 v28, v12, v28
    v_mfma_f32_32x32x16_bf16 v[48:63], v[92:95], a[72:75], v[48:63]
    ds_read_b128 v[84:87], v255 offset:35840
    v_fma_f32 v112, v112, v104, v104
    v_rcp_f32 v112, v112
    v_mul_f32 v113, v13, v13
    s_waitcnt lgkmcnt(4)
    v_mfma_f32_32x32x16_bf16 v[32:47], v[64:67], a[76:79], v[32:47]
    ds_read_b128 v[88:91], v255 offset:36864
    v_fma_f32 v113, v113, v102, v100
    v_mul_f32 v113, v113, v13
    v_exp_f32 v113, v113
    v_mul_f32 v29, v13, v29
    v_mfma_f32_32x32x16_bf16 v[48:63], v[68:71], a[76:79], v[48:63]
    ds_read_b128 v[92:95], v255 offset:37888
    buffer_load_dwordx4 v255, s[4:7], s71 offen offset:3072 sc1 lds
    v_fma_f32 v113, v113, v104, v104
    v_rcp_f32 v113, v113
    s_waitcnt lgkmcnt(4)
    v_mfma_f32_32x32x16_bf16 v[32:47], v[72:75], a[80:83], v[32:47]
    ds_read_b128 v[64:67], v255 offset:38912
    v_mul_f32 v28, v28, v112
    v_mul_f32 v29, v29, v113
    v_cvt_pk_bf16_f32 v122, v28, v29
    v_mul_f32 v114, v14, v14
    v_fma_f32 v114, v114, v102, v100
    v_mfma_f32_32x32x16_bf16 v[48:63], v[76:79], a[80:83], v[48:63]
    ds_read_b128 v[68:71], v255 offset:39936
    v_mul_f32 v114, v114, v14
    v_exp_f32 v114, v114
    v_mul_f32 v30, v14, v30
    s_waitcnt lgkmcnt(4)
    v_mfma_f32_32x32x16_bf16 v[32:47], v[80:83], a[84:87], v[32:47]
    ds_read_b128 v[72:75], v255 offset:40960
    s_mul_i32 s70, s16, 2048
    s_add_u32 m0, s70, 147456
    s_add_u32 s71, s70, s23
    s_add_u32 s71, s71, 237568
    buffer_load_dwordx4 v255, s[4:7], s71 offen offset:0 sc1 lds
    v_mfma_f32_32x32x16_bf16 v[48:63], v[84:87], a[84:87], v[48:63]
    ds_read_b128 v[76:79], v255 offset:41984
    v_fma_f32 v114, v114, v104, v104
    v_rcp_f32 v114, v114
    v_mul_f32 v115, v15, v15
    s_waitcnt lgkmcnt(4)
    v_mfma_f32_32x32x16_bf16 v[32:47], v[88:91], a[88:91], v[32:47]
    ds_read_b128 v[80:83], v255 offset:43008
    v_fma_f32 v115, v115, v102, v100
    v_mul_f32 v115, v115, v15
    v_exp_f32 v115, v115
    v_mul_f32 v31, v15, v31
    v_mfma_f32_32x32x16_bf16 v[48:63], v[92:95], a[88:91], v[48:63]
    ds_read_b128 v[84:87], v255 offset:44032
    buffer_load_dwordx4 v255, s[4:7], s71 offen offset:1024 sc1 lds
    v_fma_f32 v115, v115, v104, v104
    v_rcp_f32 v115, v115
    s_waitcnt lgkmcnt(4)
    v_mfma_f32_32x32x16_bf16 v[32:47], v[64:67], a[92:95], v[32:47]
    ds_read_b128 v[88:91], v255 offset:45056
    v_mul_f32 v30, v30, v114
    v_mul_f32 v31, v31, v115
    v_cvt_pk_bf16_f32 v123, v30, v31
    buffer_store_dwordx4 v[120:123], v255, s[4:7], s28 offen offset:1024 sc1
    v_mfma_f32_32x32x16_bf16 v[48:63], v[68:71], a[92:95], v[48:63]
    ds_read_b128 v[92:95], v255 offset:46080
    s_waitcnt lgkmcnt(4)
    v_mfma_f32_32x32x16_bf16 v[32:47], v[72:75], a[96:99], v[32:47]
    ds_read_b128 v[64:67], v255 offset:47104
    buffer_load_dwordx4 a[192:195], v255, s[4:7], s74 offen offset:1024 sc1
    v_mfma_f32_32x32x16_bf16 v[48:63], v[76:79], a[96:99], v[48:63]
    ds_read_b128 v[68:71], v255 offset:48128
    s_waitcnt lgkmcnt(4)
    v_mfma_f32_32x32x16_bf16 v[32:47], v[80:83], a[100:103], v[32:47]
    ds_read_b128 v[72:75], v255 offset:49152
    v_mfma_f32_32x32x16_bf16 v[48:63], v[84:87], a[100:103], v[48:63]
    ds_read_b128 v[76:79], v255 offset:50176
    buffer_load_dwordx4 a[196:199], v255, s[4:7], s74 offen offset:2048 sc1
    s_waitcnt lgkmcnt(4)
    v_mfma_f32_32x32x16_bf16 v[32:47], v[88:91], a[104:107], v[32:47]
    ds_read_b128 v[80:83], v255 offset:51200
    v_mfma_f32_32x32x16_bf16 v[48:63], v[92:95], a[104:107], v[48:63]
    ds_read_b128 v[84:87], v255 offset:52224
    s_waitcnt lgkmcnt(4)
    v_mfma_f32_32x32x16_bf16 v[32:47], v[64:67], a[108:111], v[32:47]
    ds_read_b128 v[88:91], v255 offset:53248
    buffer_load_dwordx4 a[200:203], v255, s[4:7], s74 offen offset:3072 sc1
    v_mfma_f32_32x32x16_bf16 v[48:63], v[68:71], a[108:111], v[48:63]
    ds_read_b128 v[92:95], v255 offset:54272
    s_waitcnt lgkmcnt(4)
    v_mfma_f32_32x32x16_bf16 v[32:47], v[72:75], a[112:115], v[32:47]
    ds_read_b128 v[64:67], v255 offset:55296
    v_mfma_f32_32x32x16_bf16 v[48:63], v[76:79], a[112:115], v[48:63]
    ds_read_b128 v[68:71], v255 offset:56320
    s_add_u32 s74, s74, 4096
    buffer_load_dwordx4 a[204:207], v255, s[4:7], s74 offen offset:0 sc1
    s_waitcnt lgkmcnt(4)
    v_mfma_f32_32x32x16_bf16 v[32:47], v[80:83], a[116:119], v[32:47]
    ds_read_b128 v[72:75], v255 offset:57344
    v_mfma_f32_32x32x16_bf16 v[48:63], v[84:87], a[116:119], v[48:63]
    ds_read_b128 v[76:79], v255 offset:58368
    s_waitcnt lgkmcnt(4)
    v_mfma_f32_32x32x16_bf16 v[32:47], v[88:91], a[120:123], v[32:47]
    ds_read_b128 v[80:83], v255 offset:59392
    buffer_load_dwordx4 a[208:211], v255, s[4:7], s74 offen offset:1024 sc1
    v_mfma_f32_32x32x16_bf16 v[48:63], v[92:95], a[120:123], v[48:63]
    ds_read_b128 v[84:87], v255 offset:60416
    s_waitcnt lgkmcnt(4)
    v_mfma_f32_32x32x16_bf16 v[32:47], v[64:67], a[124:127], v[32:47]
    ds_read_b128 v[88:91], v255 offset:61440
    v_mfma_f32_32x32x16_bf16 v[48:63], v[68:71], a[124:127], v[48:63]
    ds_read_b128 v[92:95], v255 offset:62464
    buffer_load_dwordx4 a[212:215], v255, s[4:7], s74 offen offset:2048 sc1
    s_waitcnt lgkmcnt(4)
    v_mfma_f32_32x32x16_bf16 v[32:47], v[72:75], a[128:131], v[32:47]
    ds_read_b128 v[64:67], v255 offset:63488
    v_mfma_f32_32x32x16_bf16 v[48:63], v[76:79], a[128:131], v[48:63]
    ds_read_b128 v[68:71], v255 offset:64512
    s_waitcnt lgkmcnt(4)
    v_mfma_f32_32x32x16_bf16 v[32:47], v[80:83], a[132:135], v[32:47]
    s_waitcnt vmcnt(13)
    s_barrier
    ds_read_b128 v[72:75], v106 offset:0
    buffer_load_dwordx4 a[216:219], v255, s[4:7], s74 offen offset:3072 sc1
    v_mfma_f32_32x32x16_bf16 v[48:63], v[84:87], a[132:135], v[48:63]
    ds_read_b128 v[76:79], v106 offset:1024
    s_waitcnt lgkmcnt(4)
    v_mfma_f32_32x32x16_bf16 v[32:47], v[88:91], a[136:139], v[32:47]
    ds_read_b128 v[80:83], v106 offset:2048
    v_mfma_f32_32x32x16_bf16 v[48:63], v[92:95], a[136:139], v[48:63]
    ds_read_b128 v[84:87], v106 offset:3072
    s_add_u32 s74, s74, 4096
    buffer_load_dwordx4 a[220:223], v255, s[4:7], s74 offen offset:0 sc1
    s_waitcnt lgkmcnt(4)
    v_mfma_f32_32x32x16_bf16 v[32:47], v[64:67], a[140:143], v[32:47]
    ds_read_b128 v[88:91], v106 offset:4096
    v_mfma_f32_32x32x16_bf16 v[48:63], v[68:71], a[140:143], v[48:63]
    ds_read_b128 v[92:95], v106 offset:5120
    s_waitcnt lgkmcnt(4)
    v_mfma_f32_32x32x16_bf16 v[32:47], v[72:75], a[144:147], v[32:47]
    ds_read_b128 v[64:67], v106 offset:6144
    buffer_load_dwordx4 a[224:227], v255, s[4:7], s74 offen offset:1024 sc1
    v_mfma_f32_32x32x16_bf16 v[48:63], v[76:79], a[144:147], v[48:63]
    ds_read_b128 v[68:71], v106 offset:7168
    s_waitcnt lgkmcnt(4)
    v_mfma_f32_32x32x16_bf16 v[32:47], v[80:83], a[148:151], v[32:47]
    ds_read_b128 v[72:75], v107 offset:26624
    v_mfma_f32_32x32x16_bf16 v[48:63], v[84:87], a[148:151], v[48:63]
    ds_read_b128 v[76:79], v107 offset:27648
    buffer_load_dwordx4 a[228:231], v255, s[4:7], s74 offen offset:2048 sc1
    s_waitcnt lgkmcnt(4)
    v_mfma_f32_32x32x16_bf16 v[32:47], v[88:91], a[152:155], v[32:47]
    ds_read_b128 v[80:83], v106 offset:8192
    v_mfma_f32_32x32x16_bf16 v[48:63], v[92:95], a[152:155], v[48:63]
    ds_read_b128 v[84:87], v106 offset:9216
    s_waitcnt lgkmcnt(4)
    v_mfma_f32_32x32x16_bf16 v[32:47], v[64:67], a[156:159], v[32:47]
    ds_read_b128 v[88:91], v106 offset:10240
    buffer_load_dwordx4 a[232:235], v255, s[4:7], s74 offen offset:3072 sc1
    v_mfma_f32_32x32x16_bf16 v[48:63], v[68:71], a[156:159], v[48:63]
    ds_read_b128 v[92:95], v106 offset:11264
    s_waitcnt lgkmcnt(4)
    v_mfma_f32_32x32x16_bf16 v[32:47], v[72:75], v[96:99], v[32:47]
    ds_read_b128 v[64:67], v106 offset:12288
    s_add_u32 s24, s93, 30310400
    s_waitcnt vmcnt(11)
    s_mov_b64 exec, 255
    buffer_store_dwordx4 v[252:255], v255, s[4:7], s24 offen sc1
    s_mov_b64 exec, -1
    v_mfma_f32_32x32x16_bf16 v[48:63], v[76:79], v[96:99], v[48:63]
    ds_read_b128 v[68:71], v106 offset:13312
    s_add_u32 s74, s74, 4096
    buffer_load_dwordx4 a[236:239], v255, s[4:7], s74 offen offset:0 sc1
    s_waitcnt lgkmcnt(4)
    v_mfma_f32_32x32x16_bf16 v[0:15], v[80:83], a[0:3], 0
    ds_read_b128 v[72:75], v106 offset:14336
    v_mfma_f32_32x32x16_bf16 v[16:31], v[84:87], a[0:3], 0
    ds_read_b128 v[76:79], v106 offset:15360
    s_waitcnt lgkmcnt(4)
    v_mfma_f32_32x32x16_bf16 v[0:15], v[88:91], a[4:7], v[0:15]
    ds_read_b128 v[80:83], v106 offset:16384
    buffer_load_dwordx4 v[132:135], v255, s[4:7], s74 offen offset:1024 sc1
    v_mul_f32 v108, v32, v32
    v_fma_f32 v108, v108, v102, v100
    v_mul_f32 v108, v108, v32
    v_mfma_f32_32x32x16_bf16 v[16:31], v[92:95], a[4:7], v[16:31]
    ds_read_b128 v[84:87], v106 offset:17408
    v_exp_f32 v108, v108
    v_mul_f32 v48, v32, v48
    v_fma_f32 v108, v108, v104, v104
    s_waitcnt lgkmcnt(4)
    v_mfma_f32_32x32x16_bf16 v[0:15], v[64:67], a[8:11], v[0:15]
    ds_read_b128 v[88:91], v106 offset:18432
    v_rcp_f32 v108, v108
    v_mul_f32 v109, v33, v33
    v_fma_f32 v109, v109, v102, v100
    v_mul_f32 v109, v109, v33
    v_mfma_f32_32x32x16_bf16 v[16:31], v[68:71], a[8:11], v[16:31]
    ds_read_b128 v[92:95], v106 offset:19456
    buffer_load_dwordx4 v[136:139], v255, s[4:7], s74 offen offset:2048 sc1
    v_exp_f32 v109, v109
    v_mul_f32 v49, v33, v49
    s_waitcnt lgkmcnt(4)
    v_mfma_f32_32x32x16_bf16 v[0:15], v[72:75], a[12:15], v[0:15]
    ds_read_b128 v[64:67], v106 offset:20480
    v_fma_f32 v109, v109, v104, v104
    v_rcp_f32 v109, v109
    v_mul_f32 v48, v48, v108
    v_mul_f32 v49, v49, v109
    v_mfma_f32_32x32x16_bf16 v[16:31], v[76:79], a[12:15], v[16:31]
    ds_read_b128 v[68:71], v106 offset:21504
    v_cvt_pk_bf16_f32 v116, v48, v49
    v_mul_f32 v110, v34, v34
    v_fma_f32 v110, v110, v102, v100
    v_mul_f32 v110, v110, v34
    s_waitcnt lgkmcnt(4)
    v_mfma_f32_32x32x16_bf16 v[0:15], v[80:83], a[16:19], v[0:15]
    ds_read_b128 v[72:75], v106 offset:22528
    buffer_load_dwordx4 v[140:143], v255, s[4:7], s74 offen offset:3072 sc1
    v_exp_f32 v110, v110
    v_mul_f32 v50, v34, v50
    v_fma_f32 v110, v110, v104, v104
    v_mfma_f32_32x32x16_bf16 v[16:31], v[84:87], a[16:19], v[16:31]
    ds_read_b128 v[76:79], v106 offset:23552
    v_rcp_f32 v110, v110
    v_mul_f32 v111, v35, v35
    v_fma_f32 v111, v111, v102, v100
    s_waitcnt lgkmcnt(4)
    v_mfma_f32_32x32x16_bf16 v[0:15], v[88:91], a[20:23], v[0:15]
    ds_read_b128 v[80:83], v106 offset:24576
    v_mul_f32 v111, v111, v35
    v_exp_f32 v111, v111
    v_mul_f32 v51, v35, v51
    v_fma_f32 v111, v111, v104, v104
    v_mfma_f32_32x32x16_bf16 v[16:31], v[92:95], a[20:23], v[16:31]
    ds_read_b128 v[84:87], v106 offset:25600
    s_add_u32 s74, s74, 4096
    buffer_load_dwordx4 v[144:147], v255, s[4:7], s74 offen offset:0 sc1
    v_rcp_f32 v111, v111
    s_waitcnt lgkmcnt(4)
    v_mfma_f32_32x32x16_bf16 v[0:15], v[64:67], a[24:27], v[0:15]
    ds_read_b128 v[88:91], v106 offset:26624
    v_mul_f32 v50, v50, v110
    v_mul_f32 v51, v51, v111
    v_cvt_pk_bf16_f32 v117, v50, v51
    v_mul_f32 v112, v36, v36
    v_fma_f32 v112, v112, v102, v100
    v_mfma_f32_32x32x16_bf16 v[16:31], v[68:71], a[24:27], v[16:31]
    ds_read_b128 v[92:95], v106 offset:27648
    v_mul_f32 v112, v112, v36
    v_exp_f32 v112, v112
    v_mul_f32 v52, v36, v52
    s_waitcnt lgkmcnt(4)
    v_mfma_f32_32x32x16_bf16 v[0:15], v[72:75], a[28:31], v[0:15]
    ds_read_b128 v[64:67], v106 offset:28672
    buffer_load_dwordx4 v[148:151], v255, s[4:7], s74 offen offset:1024 sc1
    v_fma_f32 v112, v112, v104, v104
    v_rcp_f32 v112, v112
    v_mul_f32 v113, v37, v37
    v_mfma_f32_32x32x16_bf16 v[16:31], v[76:79], a[28:31], v[16:31]
    ds_read_b128 v[68:71], v106 offset:29696
    v_fma_f32 v113, v113, v102, v100
    v_mul_f32 v113, v113, v37
    v_exp_f32 v113, v113
    s_waitcnt lgkmcnt(4)
    v_mfma_f32_32x32x16_bf16 v[0:15], v[80:83], a[32:35], v[0:15]
    ds_read_b128 v[72:75], v106 offset:30720
    v_mul_f32 v53, v37, v53
    v_fma_f32 v113, v113, v104, v104
    v_rcp_f32 v113, v113
    v_mul_f32 v52, v52, v112
    v_mfma_f32_32x32x16_bf16 v[16:31], v[84:87], a[32:35], v[16:31]
    ds_read_b128 v[76:79], v106 offset:31744
    buffer_load_dwordx4 v[152:155], v255, s[4:7], s74 offen offset:2048 sc1
    v_mul_f32 v53, v53, v113
    v_cvt_pk_bf16_f32 v118, v52, v53
    v_mul_f32 v114, v38, v38
    s_waitcnt lgkmcnt(4)
    v_mfma_f32_32x32x16_bf16 v[0:15], v[88:91], a[36:39], v[0:15]
    ds_read_b128 v[80:83], v106 offset:32768
    v_fma_f32 v114, v114, v102, v100
    v_mul_f32 v114, v114, v38
    v_exp_f32 v114, v114
    v_mul_f32 v54, v38, v54
    v_mfma_f32_32x32x16_bf16 v[16:31], v[92:95], a[36:39], v[16:31]
    ds_read_b128 v[84:87], v106 offset:33792
    v_fma_f32 v114, v114, v104, v104
    v_rcp_f32 v114, v114
    v_mul_f32 v115, v39, v39
    s_waitcnt lgkmcnt(4)
    v_mfma_f32_32x32x16_bf16 v[0:15], v[64:67], a[40:43], v[0:15]
    ds_read_b128 v[88:91], v106 offset:34816
    buffer_load_dwordx4 v[156:159], v255, s[4:7], s74 offen offset:3072 sc1
    v_fma_f32 v115, v115, v102, v100
    v_mul_f32 v115, v115, v39
    v_exp_f32 v115, v115
    v_mfma_f32_32x32x16_bf16 v[16:31], v[68:71], a[40:43], v[16:31]
    ds_read_b128 v[92:95], v106 offset:35840
    v_mul_f32 v55, v39, v55
    v_fma_f32 v115, v115, v104, v104
    v_rcp_f32 v115, v115
    s_waitcnt lgkmcnt(4)
    v_mfma_f32_32x32x16_bf16 v[0:15], v[72:75], a[44:47], v[0:15]
    ds_read_b128 v[64:67], v106 offset:36864
    v_mul_f32 v54, v54, v114
    v_mul_f32 v55, v55, v115
    v_cvt_pk_bf16_f32 v119, v54, v55
    buffer_store_dwordx4 v[116:119], v255, s[4:7], s28 offen offset:2048 sc1
    v_mul_f32 v108, v40, v40
    v_mfma_f32_32x32x16_bf16 v[16:31], v[76:79], a[44:47], v[16:31]
    ds_read_b128 v[68:71], v106 offset:37888
    s_add_u32 s74, s74, 4096
    buffer_load_dwordx4 a[0:3], v255, s[4:7], s74 offen offset:0 sc1
    v_fma_f32 v108, v108, v102, v100
    v_mul_f32 v108, v108, v40
    s_waitcnt lgkmcnt(4)
    v_mfma_f32_32x32x16_bf16 v[0:15], v[80:83], a[48:51], v[0:15]
    ds_read_b128 v[72:75], v106 offset:38912
    v_exp_f32 v108, v108
    v_mul_f32 v56, v40, v56
    v_fma_f32 v108, v108, v104, v104
    v_mfma_f32_32x32x16_bf16 v[16:31], v[84:87], a[48:51], v[16:31]
    ds_read_b128 v[76:79], v106 offset:39936
    v_rcp_f32 v108, v108
    v_mul_f32 v109, v41, v41
    v_fma_f32 v109, v109, v102, v100
    s_waitcnt lgkmcnt(4)
    v_mfma_f32_32x32x16_bf16 v[0:15], v[88:91], a[52:55], v[0:15]
    ds_read_b128 v[80:83], v106 offset:40960
    buffer_load_dwordx4 a[4:7], v255, s[4:7], s74 offen offset:1024 sc1
    v_mul_f32 v109, v109, v41
    v_exp_f32 v109, v109
    v_mul_f32 v57, v41, v57
    v_mfma_f32_32x32x16_bf16 v[16:31], v[92:95], a[52:55], v[16:31]
    ds_read_b128 v[84:87], v106 offset:41984
    v_fma_f32 v109, v109, v104, v104
    v_rcp_f32 v109, v109
    v_mul_f32 v56, v56, v108
    s_waitcnt lgkmcnt(4)
    v_mfma_f32_32x32x16_bf16 v[0:15], v[64:67], a[56:59], v[0:15]
    ds_read_b128 v[88:91], v106 offset:43008
    v_mul_f32 v57, v57, v109
    v_cvt_pk_bf16_f32 v120, v56, v57
    v_mul_f32 v110, v42, v42
    v_fma_f32 v110, v110, v102, v100
    v_mul_f32 v110, v110, v42
    v_mfma_f32_32x32x16_bf16 v[16:31], v[68:71], a[56:59], v[16:31]
    ds_read_b128 v[92:95], v106 offset:44032
    buffer_load_dwordx4 a[8:11], v255, s[4:7], s74 offen offset:2048 sc1
    v_exp_f32 v110, v110
    v_mul_f32 v58, v42, v58
    s_waitcnt lgkmcnt(4)
    v_mfma_f32_32x32x16_bf16 v[0:15], v[72:75], a[60:63], v[0:15]
    ds_read_b128 v[64:67], v106 offset:45056
    s_add_u32 s25, s95, 30310400
    buffer_load_dword v251, v250, s[4:7], s25 offen sc1
    v_fma_f32 v110, v110, v104, v104
    v_rcp_f32 v110, v110
    v_mfma_f32_32x32x16_bf16 v[16:31], v[76:79], a[60:63], v[16:31]
    ds_read_b128 v[68:71], v106 offset:46080
    v_mul_f32 v111, v43, v43
    v_fma_f32 v111, v111, v102, v100
    v_mul_f32 v111, v111, v43
    s_waitcnt lgkmcnt(4)
    v_mfma_f32_32x32x16_bf16 v[0:15], v[80:83], a[64:67], v[0:15]
    ds_read_b128 v[72:75], v106 offset:47104
    buffer_load_dwordx4 a[12:15], v255, s[4:7], s74 offen offset:3072 sc1
    v_exp_f32 v111, v111
    v_mul_f32 v59, v43, v59
    v_fma_f32 v111, v111, v104, v104
    v_mfma_f32_32x32x16_bf16 v[16:31], v[84:87], a[64:67], v[16:31]
    ds_read_b128 v[76:79], v106 offset:48128
    v_rcp_f32 v111, v111
    v_mul_f32 v58, v58, v110
    v_mul_f32 v59, v59, v111
    s_waitcnt lgkmcnt(4)
    v_mfma_f32_32x32x16_bf16 v[0:15], v[88:91], a[68:71], v[0:15]
    ds_read_b128 v[80:83], v106 offset:49152
    v_cvt_pk_bf16_f32 v121, v58, v59
    v_mul_f32 v112, v44, v44
    v_fma_f32 v112, v112, v102, v100
    v_mul_f32 v112, v112, v44
    v_mfma_f32_32x32x16_bf16 v[16:31], v[92:95], a[68:71], v[16:31]
    ds_read_b128 v[84:87], v106 offset:50176
    s_add_u32 s74, s74, 4096
    buffer_load_dwordx4 a[16:19], v255, s[4:7], s74 offen offset:0 sc1
    v_exp_f32 v112, v112
    s_waitcnt lgkmcnt(4)
    v_mfma_f32_32x32x16_bf16 v[0:15], v[64:67], a[72:75], v[0:15]
    ds_read_b128 v[88:91], v106 offset:51200
    v_mul_f32 v60, v44, v60
    v_fma_f32 v112, v112, v104, v104
    v_rcp_f32 v112, v112
    v_mul_f32 v113, v45, v45
    v_mfma_f32_32x32x16_bf16 v[16:31], v[68:71], a[72:75], v[16:31]
    ds_read_b128 v[92:95], v106 offset:52224
    v_fma_f32 v113, v113, v102, v100
    v_mul_f32 v113, v113, v45
    v_exp_f32 v113, v113
    s_waitcnt lgkmcnt(4)
    v_mfma_f32_32x32x16_bf16 v[0:15], v[72:75], a[76:79], v[0:15]
    ds_read_b128 v[64:67], v106 offset:53248
    buffer_load_dwordx4 a[20:23], v255, s[4:7], s74 offen offset:1024 sc1
    v_mul_f32 v61, v45, v61
    v_fma_f32 v113, v113, v104, v104
    v_rcp_f32 v113, v113
    v_mfma_f32_32x32x16_bf16 v[16:31], v[76:79], a[76:79], v[16:31]
    ds_read_b128 v[68:71], v106 offset:54272
    v_mul_f32 v60, v60, v112
    v_mul_f32 v61, v61, v113
    v_cvt_pk_bf16_f32 v122, v60, v61
    v_mul_f32 v114, v46, v46
    s_waitcnt lgkmcnt(4)
    v_mfma_f32_32x32x16_bf16 v[0:15], v[80:83], a[80:83], v[0:15]
    ds_read_b128 v[72:75], v106 offset:55296
    v_fma_f32 v114, v114, v102, v100
    v_mul_f32 v114, v114, v46
    v_exp_f32 v114, v114
    v_mul_f32 v62, v46, v62
    v_mfma_f32_32x32x16_bf16 v[16:31], v[84:87], a[80:83], v[16:31]
    ds_read_b128 v[76:79], v106 offset:56320
    buffer_load_dwordx4 a[24:27], v255, s[4:7], s74 offen offset:2048 sc1
    v_fma_f32 v114, v114, v104, v104
    v_rcp_f32 v114, v114
    s_waitcnt lgkmcnt(4)
    v_mfma_f32_32x32x16_bf16 v[0:15], v[88:91], a[84:87], v[0:15]
    ds_read_b128 v[80:83], v106 offset:57344
    v_mul_f32 v115, v47, v47
    v_fma_f32 v115, v115, v102, v100
    v_mul_f32 v115, v115, v47
    v_exp_f32 v115, v115
    v_mfma_f32_32x32x16_bf16 v[16:31], v[92:95], a[84:87], v[16:31]
    ds_read_b128 v[84:87], v106 offset:58368
    v_mul_f32 v63, v47, v63
    v_fma_f32 v115, v115, v104, v104
    v_rcp_f32 v115, v115
    s_waitcnt lgkmcnt(4)
    v_mfma_f32_32x32x16_bf16 v[0:15], v[64:67], a[88:91], v[0:15]
    ds_read_b128 v[88:91], v106 offset:59392
    buffer_load_dwordx4 a[28:31], v255, s[4:7], s74 offen offset:3072 sc1
    v_mul_f32 v62, v62, v114
    v_mul_f32 v63, v63, v115
    v_cvt_pk_bf16_f32 v123, v62, v63
    buffer_store_dwordx4 v[120:123], v255, s[4:7], s28 offen offset:3072 sc1
    v_mfma_f32_32x32x16_bf16 v[16:31], v[68:71], a[88:91], v[16:31]
    ds_read_b128 v[92:95], v106 offset:60416
    s_waitcnt lgkmcnt(4)
    v_mfma_f32_32x32x16_bf16 v[0:15], v[72:75], a[92:95], v[0:15]
    ds_read_b128 v[64:67], v106 offset:61440
    v_mfma_f32_32x32x16_bf16 v[16:31], v[76:79], a[92:95], v[16:31]
    ds_read_b128 v[68:71], v106 offset:62464
    s_waitcnt lgkmcnt(4)
    v_mfma_f32_32x32x16_bf16 v[0:15], v[80:83], a[96:99], v[0:15]
    ds_read_b128 v[72:75], v106 offset:63488
    v_mfma_f32_32x32x16_bf16 v[16:31], v[84:87], a[96:99], v[16:31]
    ds_read_b128 v[76:79], v106 offset:64512
    s_waitcnt lgkmcnt(4)
    v_mfma_f32_32x32x16_bf16 v[0:15], v[88:91], a[100:103], v[0:15]
    s_barrier
    ds_read_b128 v[80:83], v107 offset:0
    v_mfma_f32_32x32x16_bf16 v[16:31], v[92:95], a[100:103], v[16:31]
    ds_read_b128 v[84:87], v107 offset:1024
    s_waitcnt lgkmcnt(4)
    v_mfma_f32_32x32x16_bf16 v[0:15], v[64:67], a[104:107], v[0:15]
    ds_read_b128 v[88:91], v107 offset:2048
    v_mfma_f32_32x32x16_bf16 v[16:31], v[68:71], a[104:107], v[16:31]
    ds_read_b128 v[92:95], v107 offset:3072
    s_waitcnt lgkmcnt(4)
    v_mfma_f32_32x32x16_bf16 v[0:15], v[72:75], a[108:111], v[0:15]
    ds_read_b128 v[64:67], v107 offset:4096
    v_mfma_f32_32x32x16_bf16 v[16:31], v[76:79], a[108:111], v[16:31]
    ds_read_b128 v[68:71], v107 offset:5120
    s_waitcnt lgkmcnt(4)
    v_mfma_f32_32x32x16_bf16 v[0:15], v[80:83], a[112:115], v[0:15]
    ds_read_b128 v[72:75], v107 offset:6144
    s_waitcnt vmcnt(6)
    v_cmp_ne_u32 vcc, s64, v251
    s_cbranch_vccz L_pdone_h0
    s_mov_b32 s65, 0x20000
L_poll_h0:
    buffer_load_dword v244, v250, s[4:7], s25 offen sc1
    s_waitcnt vmcnt(0)
    v_cmp_ne_u32 vcc, s64, v244
    s_cbranch_vccz L_pdone_h0
    s_sub_u32 s65, s65, 1
    s_cbranch_scc0 L_poll_h0
L_pdone_h0:
    v_mfma_f32_32x32x16_bf16 v[16:31], v[84:87], a[112:115], v[16:31]
    ds_read_b128 v[76:79], v107 offset:7168
    buffer_load_dwordx4 a[48:51], v124, s[4:7], s96 offen sc1
    s_waitcnt lgkmcnt(4)
    v_mfma_f32_32x32x16_bf16 v[0:15], v[88:91], a[116:119], v[0:15]
    ds_read_b128 v[80:83], v107 offset:8192
    v_mfma_f32_32x32x16_bf16 v[16:31], v[92:95], a[116:119], v[16:31]
    ds_read_b128 v[84:87], v107 offset:9216
    buffer_load_dwordx4 a[52:55], v125, s[4:7], s96 offen sc1
    s_waitcnt lgkmcnt(4)
    v_mfma_f32_32x32x16_bf16 v[0:15], v[64:67], a[120:123], v[0:15]
    ds_read_b128 v[88:91], v107 offset:10240
    v_mfma_f32_32x32x16_bf16 v[16:31], v[68:71], a[120:123], v[16:31]
    ds_read_b128 v[92:95], v107 offset:11264
    buffer_load_dwordx4 a[56:59], v126, s[4:7], s96 offen sc1
    s_waitcnt lgkmcnt(4)
    v_mfma_f32_32x32x16_bf16 v[0:15], v[72:75], a[124:127], v[0:15]
    ds_read_b128 v[64:67], v107 offset:12288
    v_mfma_f32_32x32x16_bf16 v[16:31], v[76:79], a[124:127], v[16:31]
    ds_read_b128 v[68:71], v107 offset:13312
    buffer_load_dwordx4 a[60:63], v127, s[4:7], s96 offen sc1
    s_waitcnt lgkmcnt(4)
    v_mfma_f32_32x32x16_bf16 v[0:15], v[80:83], a[128:131], v[0:15]
    ds_read_b128 v[72:75], v107 offset:14336
    v_mfma_f32_32x32x16_bf16 v[16:31], v[84:87], a[128:131], v[16:31]
    ds_read_b128 v[76:79], v107 offset:15360
    buffer_load_dwordx4 a[64:67], v124, s[4:7], s97 offen sc1
    s_waitcnt lgkmcnt(4)
    v_mfma_f32_32x32x16_bf16 v[0:15], v[88:91], a[132:135], v[0:15]
    ds_read_b128 v[80:83], v107 offset:16384
    v_mfma_f32_32x32x16_bf16 v[16:31], v[92:95], a[132:135], v[16:31]
    ds_read_b128 v[84:87], v107 offset:17408
    buffer_load_dwordx4 a[68:71], v125, s[4:7], s97 offen sc1
    s_waitcnt lgkmcnt(4)
    v_mfma_f32_32x32x16_bf16 v[0:15], v[64:67], a[136:139], v[0:15]
    ds_read_b128 v[88:91], v107 offset:18432
    v_mfma_f32_32x32x16_bf16 v[16:31], v[68:71], a[136:139], v[16:31]
    ds_read_b128 v[92:95], v107 offset:19456
    buffer_load_dwordx4 a[72:75], v126, s[4:7], s97 offen sc1
    s_waitcnt lgkmcnt(4)
    v_mfma_f32_32x32x16_bf16 v[0:15], v[72:75], a[140:143], v[0:15]
    ds_read_b128 v[64:67], v107 offset:20480
    v_mfma_f32_32x32x16_bf16 v[16:31], v[76:79], a[140:143], v[16:31]
    ds_read_b128 v[68:71], v107 offset:21504
    buffer_load_dwordx4 a[76:79], v127, s[4:7], s97 offen sc1
    s_waitcnt lgkmcnt(4)
    v_mfma_f32_32x32x16_bf16 v[0:15], v[80:83], a[144:147], v[0:15]
    ds_read_b128 v[72:75], v107 offset:22528
    v_mfma_f32_32x32x16_bf16 v[16:31], v[84:87], a[144:147], v[16:31]
    ds_read_b128 v[76:79], v107 offset:23552
    buffer_load_dwordx4 a[80:83], v124, s[4:7], s98 offen sc1
    s_waitcnt lgkmcnt(4)
    v_mfma_f32_32x32x16_bf16 v[0:15], v[88:91], a[148:151], v[0:15]
    ds_read_b128 v[80:83], v107 offset:28672
    v_mfma_f32_32x32x16_bf16 v[16:31], v[92:95], a[148:151], v[16:31]
    ds_read_b128 v[84:87], v107 offset:29696
    buffer_load_dwordx4 a[84:87], v125, s[4:7], s98 offen sc1
    s_waitcnt lgkmcnt(4)
    v_mfma_f32_32x32x16_bf16 v[0:15], v[64:67], a[152:155], v[0:15]
    v_mfma_f32_32x32x16_bf16 v[16:31], v[68:71], a[152:155], v[16:31]
    buffer_load_dwordx4 a[88:91], v126, s[4:7], s98 offen sc1
    s_waitcnt lgkmcnt(2)
    v_mfma_f32_32x32x16_bf16 v[0:15], v[72:75], a[156:159], v[0:15]
    v_mfma_f32_32x32x16_bf16 v[16:31], v[76:79], a[156:159], v[16:31]
    buffer_load_dwordx4 a[92:95], v127, s[4:7], s98 offen sc1
    s_waitcnt lgkmcnt(0)
    v_mfma_f32_32x32x16_bf16 v[0:15], v[80:83], v[96:99], v[0:15]
    s_add_u32 s24, s93, 30441472
    s_waitcnt vmcnt(12)
    s_mov_b64 exec, 255
    buffer_store_dwordx4 v[252:255], v255, s[4:7], s24 offen sc1
    s_mov_b64 exec, -1
    v_mfma_f32_32x32x16_bf16 v[16:31], v[84:87], v[96:99], v[16:31]
    buffer_load_dwordx4 a[96:99], v124, s[4:7], s99 offen sc1
    s_nop 4
    v_pk_mul_f32 v[108:109], v[0:1], v[0:1]
    v_pk_fma_f32 v[108:109], v[108:109], v[102:103], v[100:101] op_sel_hi:[1,0,0]
    v_pk_mul_f32 v[108:109], v[108:109], v[0:1]
    v_exp_f32 v108, v108
    v_exp_f32 v109, v109
    s_nop 0
    v_pk_mul_f32 v[16:17], v[0:1], v[16:17]
    v_pk_fma_f32 v[108:109], v[108:109], v[104:105], v[104:105] op_sel_hi:[1,0,0]
    v_rcp_f32 v108, v108
    v_rcp_f32 v109, v109
    buffer_load_dwordx4 a[100:103], v125, s[4:7], s99 offen sc1
    v_pk_mul_f32 v[16:17], v[16:17], v[108:109]
    v_cvt_pk_bf16_f32 v116, v16, v17
    v_pk_mul_f32 v[110:111], v[2:3], v[2:3]
    v_pk_fma_f32 v[110:111], v[110:111], v[102:103], v[100:101] op_sel_hi:[1,0,0]
    v_pk_mul_f32 v[110:111], v[110:111], v[2:3]
    v_exp_f32 v110, v110
    v_exp_f32 v111, v111
    v_pk_mul_f32 v[18:19], v[2:3], v[18:19]
    v_pk_fma_f32 v[110:111], v[110:111], v[104:105], v[104:105] op_sel_hi:[1,0,0]
    v_rcp_f32 v110, v110
    v_rcp_f32 v111, v111
    buffer_load_dwordx4 a[104:107], v126, s[4:7], s99 offen sc1
    v_pk_mul_f32 v[18:19], v[18:19], v[110:111]
    v_cvt_pk_bf16_f32 v117, v18, v19
    v_pk_mul_f32 v[112:113], v[4:5], v[4:5]
    v_pk_fma_f32 v[112:113], v[112:113], v[102:103], v[100:101] op_sel_hi:[1,0,0]
    v_pk_mul_f32 v[112:113], v[112:113], v[4:5]
    v_exp_f32 v112, v112
    v_exp_f32 v113, v113
    v_pk_mul_f32 v[20:21], v[4:5], v[20:21]
    v_pk_fma_f32 v[112:113], v[112:113], v[104:105], v[104:105] op_sel_hi:[1,0,0]
    v_rcp_f32 v112, v112
    v_rcp_f32 v113, v113
    buffer_load_dwordx4 a[108:111], v127, s[4:7], s99 offen sc1
    v_pk_mul_f32 v[20:21], v[20:21], v[112:113]
    v_cvt_pk_bf16_f32 v118, v20, v21
    v_pk_mul_f32 v[114:115], v[6:7], v[6:7]
    v_pk_fma_f32 v[114:115], v[114:115], v[102:103], v[100:101] op_sel_hi:[1,0,0]
    v_pk_mul_f32 v[114:115], v[114:115], v[6:7]
    v_exp_f32 v114, v114
    v_exp_f32 v115, v115
    v_pk_mul_f32 v[22:23], v[6:7], v[22:23]
    v_pk_fma_f32 v[114:115], v[114:115], v[104:105], v[104:105] op_sel_hi:[1,0,0]
    v_rcp_f32 v114, v114
    v_rcp_f32 v115, v115
    s_nop 0
    v_pk_mul_f32 v[22:23], v[22:23], v[114:115]
    v_cvt_pk_bf16_f32 v119, v22, v23
    buffer_store_dwordx4 v[116:119], v255, s[4:7], s29 offen offset:0 sc1
    v_pk_mul_f32 v[108:109], v[8:9], v[8:9]
    v_pk_fma_f32 v[108:109], v[108:109], v[102:103], v[100:101] op_sel_hi:[1,0,0]
    v_pk_mul_f32 v[108:109], v[108:109], v[8:9]
    v_exp_f32 v108, v108
    v_exp_f32 v109, v109
    v_pk_mul_f32 v[24:25], v[8:9], v[24:25]
    v_pk_fma_f32 v[108:109], v[108:109], v[104:105], v[104:105] op_sel_hi:[1,0,0]
    v_rcp_f32 v108, v108
    v_rcp_f32 v109, v109
    s_nop 0
    v_pk_mul_f32 v[24:25], v[24:25], v[108:109]
    v_cvt_pk_bf16_f32 v120, v24, v25
    v_pk_mul_f32 v[110:111], v[10:11], v[10:11]
    v_pk_fma_f32 v[110:111], v[110:111], v[102:103], v[100:101] op_sel_hi:[1,0,0]
    v_pk_mul_f32 v[110:111], v[110:111], v[10:11]
    v_exp_f32 v110, v110
    v_exp_f32 v111, v111
    v_pk_mul_f32 v[26:27], v[10:11], v[26:27]
    v_pk_fma_f32 v[110:111], v[110:111], v[104:105], v[104:105] op_sel_hi:[1,0,0]
    v_rcp_f32 v110, v110
    v_rcp_f32 v111, v111
    s_nop 0
    v_pk_mul_f32 v[26:27], v[26:27], v[110:111]
    v_cvt_pk_bf16_f32 v121, v26, v27
    v_pk_mul_f32 v[112:113], v[12:13], v[12:13]
    v_pk_fma_f32 v[112:113], v[112:113], v[102:103], v[100:101] op_sel_hi:[1,0,0]
    v_pk_mul_f32 v[112:113], v[112:113], v[12:13]
    v_exp_f32 v112, v112
    v_exp_f32 v113, v113
    v_pk_mul_f32 v[28:29], v[12:13], v[28:29]
    v_pk_fma_f32 v[112:113], v[112:113], v[104:105], v[104:105] op_sel_hi:[1,0,0]
    v_rcp_f32 v112, v112
    v_rcp_f32 v113, v113
    s_nop 0
    v_pk_mul_f32 v[28:29], v[28:29], v[112:113]
    v_cvt_pk_bf16_f32 v122, v28, v29
    v_pk_mul_f32 v[114:115], v[14:15], v[14:15]
    v_pk_fma_f32 v[114:115], v[114:115], v[102:103], v[100:101] op_sel_hi:[1,0,0]
    v_pk_mul_f32 v[114:115], v[114:115], v[14:15]
    v_exp_f32 v114, v114
    v_exp_f32 v115, v115
    v_pk_mul_f32 v[30:31], v[14:15], v[30:31]
    v_pk_fma_f32 v[114:115], v[114:115], v[104:105], v[104:105] op_sel_hi:[1,0,0]
    v_rcp_f32 v114, v114
    v_rcp_f32 v115, v115
    s_nop 0
    v_pk_mul_f32 v[30:31], v[30:31], v[114:115]
    v_cvt_pk_bf16_f32 v123, v30, v31
    buffer_store_dwordx4 v[120:123], v255, s[4:7], s29 offen offset:1024 sc1
    s_barrier
    s_waitcnt vmcnt(18)
    v_mfma_f32_16x16x32_bf16 v[0:3], v[160:163], a[48:51], 0
    v_mfma_f32_16x16x32_bf16 v[4:7], v[164:167], a[48:51], 0
    s_add_u32 s74, s74, 4096
    buffer_load_dwordx4 a[32:35], v255, s[4:7], s74 offen offset:0 sc1
    v_mfma_f32_16x16x32_bf16 v[8:11], v[168:171], a[48:51], 0
    v_mfma_f32_16x16x32_bf16 v[12:15], v[172:175], a[48:51], 0
    v_mfma_f32_16x16x32_bf16 v[16:19], v[176:179], a[48:51], 0
    buffer_load_dwordx4 a[36:39], v255, s[4:7], s74 offen offset:1024 sc1
    s_waitcnt vmcnt(19)
    v_mfma_f32_16x16x32_bf16 v[0:3], v[180:183], a[52:55], v[0:3]
    v_mfma_f32_16x16x32_bf16 v[4:7], v[184:187], a[52:55], v[4:7]
    v_mfma_f32_16x16x32_bf16 v[8:11], v[188:191], a[52:55], v[8:11]
    buffer_load_dwordx4 a[40:43], v255, s[4:7], s74 offen offset:2048 sc1
    v_mfma_f32_16x16x32_bf16 v[12:15], v[192:195], a[52:55], v[12:15]
    s_add_u32 s25, s95, 30441472
    buffer_load_dword v251, v250, s[4:7], s25 offen sc1
    v_mfma_f32_16x16x32_bf16 v[16:19], v[196:199], a[52:55], v[16:19]
    s_waitcnt vmcnt(20)
    v_mfma_f32_16x16x32_bf16 v[0:3], v[200:203], a[56:59], v[0:3]
    v_mfma_f32_16x16x32_bf16 v[4:7], v[204:207], a[56:59], v[4:7]
    v_mfma_f32_16x16x32_bf16 v[8:11], v[208:211], a[56:59], v[8:11]
    v_mfma_f32_16x16x32_bf16 v[12:15], v[212:215], a[56:59], v[12:15]
    v_mfma_f32_16x16x32_bf16 v[16:19], v[216:219], a[56:59], v[16:19]
    s_waitcnt vmcnt(19)
    v_mfma_f32_16x16x32_bf16 v[0:3], v[220:223], a[60:63], v[0:3]
    v_mfma_f32_16x16x32_bf16 v[4:7], v[224:227], a[60:63], v[4:7]
    v_mfma_f32_16x16x32_bf16 v[8:11], v[228:231], a[60:63], v[8:11]
    v_mfma_f32_16x16x32_bf16 v[12:15], v[232:235], a[60:63], v[12:15]
    v_mfma_f32_16x16x32_bf16 v[16:19], v[236:239], a[60:63], v[16:19]
    s_waitcnt vmcnt(18)
    v_mfma_f32_16x16x32_bf16 v[20:23], v[160:163], a[64:67], 0
    v_mfma_f32_16x16x32_bf16 v[24:27], v[164:167], a[64:67], 0
    v_mfma_f32_16x16x32_bf16 v[28:31], v[168:171], a[64:67], 0
    v_mfma_f32_16x16x32_bf16 v[32:35], v[172:175], a[64:67], 0
    v_mfma_f32_16x16x32_bf16 v[36:39], v[176:179], a[64:67], 0
    s_waitcnt vmcnt(17)
    v_mfma_f32_16x16x32_bf16 v[20:23], v[180:183], a[68:71], v[20:23]
    v_mfma_f32_16x16x32_bf16 v[24:27], v[184:187], a[68:71], v[24:27]
    v_mfma_f32_16x16x32_bf16 v[28:31], v[188:191], a[68:71], v[28:31]
    v_mfma_f32_16x16x32_bf16 v[32:35], v[192:195], a[68:71], v[32:35]
    v_mfma_f32_16x16x32_bf16 v[36:39], v[196:199], a[68:71], v[36:39]
    s_waitcnt vmcnt(16)
    v_mfma_f32_16x16x32_bf16 v[20:23], v[200:203], a[72:75], v[20:23]
    s_add_u32 s24, s93, 30572544
    s_waitcnt vmcnt(4)
    s_mov_b64 exec, 255
    buffer_store_dwordx4 v[252:255], v255, s[4:7], s24 offen sc1
    s_mov_b64 exec, -1
    v_mfma_f32_16x16x32_bf16 v[24:27], v[204:207], a[72:75], v[24:27]
    v_mfma_f32_16x16x32_bf16 v[28:31], v[208:211], a[72:75], v[28:31]
    v_mfma_f32_16x16x32_bf16 v[32:35], v[212:215], a[72:75], v[32:35]
    v_mfma_f32_16x16x32_bf16 v[36:39], v[216:219], a[72:75], v[36:39]
    v_mfma_f32_16x16x32_bf16 v[20:23], v[220:223], a[76:79], v[20:23]
    v_mfma_f32_16x16x32_bf16 v[24:27], v[224:227], a[76:79], v[24:27]
    v_mfma_f32_16x16x32_bf16 v[28:31], v[228:231], a[76:79], v[28:31]
    v_mfma_f32_16x16x32_bf16 v[32:35], v[232:235], a[76:79], v[32:35]
    v_mfma_f32_16x16x32_bf16 v[36:39], v[236:239], a[76:79], v[36:39]
    v_mfma_f32_16x16x32_bf16 v[40:43], v[160:163], a[80:83], 0
    v_mfma_f32_16x16x32_bf16 v[44:47], v[164:167], a[80:83], 0
    v_mfma_f32_16x16x32_bf16 v[48:51], v[168:171], a[80:83], 0
    v_mfma_f32_16x16x32_bf16 v[52:55], v[172:175], a[80:83], 0
    v_mfma_f32_16x16x32_bf16 v[56:59], v[176:179], a[80:83], 0
    v_mfma_f32_16x16x32_bf16 v[40:43], v[180:183], a[84:87], v[40:43]
    v_mfma_f32_16x16x32_bf16 v[44:47], v[184:187], a[84:87], v[44:47]
    v_mfma_f32_16x16x32_bf16 v[48:51], v[188:191], a[84:87], v[48:51]
    v_mfma_f32_16x16x32_bf16 v[52:55], v[192:195], a[84:87], v[52:55]
    v_mfma_f32_16x16x32_bf16 v[56:59], v[196:199], a[84:87], v[56:59]
    v_mfma_f32_16x16x32_bf16 v[40:43], v[200:203], a[88:91], v[40:43]
    s_add_u32 s96, s96, 2048
    s_add_u32 s97, s97, 2048
    s_add_u32 s98, s98, 2048
    s_add_u32 s99, s99, 2048
    s_waitcnt vmcnt(1)
    v_cmp_ne_u32 vcc, s64, v251
    s_cbranch_vccz L_pdone_hh1
    s_mov_b32 s65, 0x20000
L_poll_hh1:
    buffer_load_dword v244, v250, s[4:7], s25 offen sc1
    s_waitcnt vmcnt(0)
    v_cmp_ne_u32 vcc, s64, v244
    s_cbranch_vccz L_pdone_hh1
    s_sub_u32 s65, s65, 1
    s_cbranch_scc0 L_poll_hh1
L_pdone_hh1:
    buffer_load_dwordx4 a[112:115], v124, s[4:7], s96 offen sc1
    buffer_load_dwordx4 a[116:119], v125, s[4:7], s96 offen sc1
    buffer_load_dwordx4 a[120:123], v126, s[4:7], s96 offen sc1
    buffer_load_dwordx4 a[124:127], v127, s[4:7], s96 offen sc1
    v_mfma_f32_16x16x32_bf16 v[44:47], v[204:207], a[88:91], v[44:47]
    v_mfma_f32_16x16x32_bf16 v[48:51], v[208:211], a[88:91], v[48:51]
    v_mfma_f32_16x16x32_bf16 v[52:55], v[212:215], a[88:91], v[52:55]
    v_mfma_f32_16x16x32_bf16 v[56:59], v[216:219], a[88:91], v[56:59]
    v_mfma_f32_16x16x32_bf16 v[40:43], v[220:223], a[92:95], v[40:43]
    buffer_load_dwordx4 a[128:131], v124, s[4:7], s97 offen sc1
    v_mfma_f32_16x16x32_bf16 v[44:47], v[224:227], a[92:95], v[44:47]
    v_mfma_f32_16x16x32_bf16 v[48:51], v[228:231], a[92:95], v[48:51]
    v_mfma_f32_16x16x32_bf16 v[52:55], v[232:235], a[92:95], v[52:55]
    v_mfma_f32_16x16x32_bf16 v[56:59], v[236:239], a[92:95], v[56:59]
    v_mfma_f32_16x16x32_bf16 v[60:63], v[160:163], a[96:99], 0
    buffer_load_dwordx4 a[132:135], v125, s[4:7], s97 offen sc1
    v_mfma_f32_16x16x32_bf16 v[64:67], v[164:167], a[96:99], 0
    v_mfma_f32_16x16x32_bf16 v[68:71], v[168:171], a[96:99], 0
    v_mfma_f32_16x16x32_bf16 v[72:75], v[172:175], a[96:99], 0
    v_mfma_f32_16x16x32_bf16 v[76:79], v[176:179], a[96:99], 0
    v_mfma_f32_16x16x32_bf16 v[60:63], v[180:183], a[100:103], v[60:63]
    buffer_load_dwordx4 a[136:139], v126, s[4:7], s97 offen sc1
    v_mfma_f32_16x16x32_bf16 v[64:67], v[184:187], a[100:103], v[64:67]
    v_mfma_f32_16x16x32_bf16 v[68:71], v[188:191], a[100:103], v[68:71]
    v_mfma_f32_16x16x32_bf16 v[72:75], v[192:195], a[100:103], v[72:75]
    v_mfma_f32_16x16x32_bf16 v[76:79], v[196:199], a[100:103], v[76:79]
    v_mfma_f32_16x16x32_bf16 v[60:63], v[200:203], a[104:107], v[60:63]
    buffer_load_dwordx4 a[140:143], v127, s[4:7], s97 offen sc1
    v_mfma_f32_16x16x32_bf16 v[64:67], v[204:207], a[104:107], v[64:67]
    v_mfma_f32_16x16x32_bf16 v[68:71], v[208:211], a[104:107], v[68:71]
    v_mfma_f32_16x16x32_bf16 v[72:75], v[212:215], a[104:107], v[72:75]
    v_mfma_f32_16x16x32_bf16 v[76:79], v[216:219], a[104:107], v[76:79]
    v_mfma_f32_16x16x32_bf16 v[60:63], v[220:223], a[108:111], v[60:63]
    buffer_load_dwordx4 a[144:147], v124, s[4:7], s98 offen sc1
    v_mfma_f32_16x16x32_bf16 v[64:67], v[224:227], a[108:111], v[64:67]
    v_mfma_f32_16x16x32_bf16 v[68:71], v[228:231], a[108:111], v[68:71]
    v_mfma_f32_16x16x32_bf16 v[72:75], v[232:235], a[108:111], v[72:75]
    v_mfma_f32_16x16x32_bf16 v[76:79], v[236:239], a[108:111], v[76:79]
    s_waitcnt vmcnt(8)
    v_mfma_f32_16x16x32_bf16 v[0:3], v[240:243], a[112:115], v[0:3]
    buffer_load_dwordx4 a[148:151], v125, s[4:7], s98 offen sc1
    v_mfma_f32_16x16x32_bf16 v[4:7], a[160:163], a[112:115], v[4:7]
    v_and_b32 v129, 48, v254
    v_mfma_f32_16x16x32_bf16 v[8:11], a[164:167], a[112:115], v[8:11]
    v_lshlrev_b32 v128, 1, v129
    v_mfma_f32_16x16x32_bf16 v[12:15], a[168:171], a[112:115], v[12:15]
    v_add_u32 v128, 162112, v128
    v_mfma_f32_16x16x32_bf16 v[16:19], a[172:175], a[112:115], v[16:19]
    v_add_u32 v129, 162112, v129
    s_waitcnt vmcnt(8)
    v_mfma_f32_16x16x32_bf16 v[0:3], a[176:179], a[116:119], v[0:3]
    buffer_load_dwordx4 a[152:155], v126, s[4:7], s98 offen sc1
    v_mfma_f32_16x16x32_bf16 v[4:7], a[180:183], a[116:119], v[4:7]
    ds_read_b128 v[84:87], v128 offset:0
    v_mfma_f32_16x16x32_bf16 v[8:11], a[184:187], a[116:119], v[8:11]
    ds_read_b128 v[88:91], v128 offset:16
    v_mfma_f32_16x16x32_bf16 v[12:15], a[188:191], a[116:119], v[12:15]
    ds_read_b128 v[92:95], v128 offset:128
    v_mfma_f32_16x16x32_bf16 v[16:19], a[192:195], a[116:119], v[16:19]
    ds_read_b128 v[96:99], v128 offset:144
    s_waitcnt vmcnt(8)
    v_mfma_f32_16x16x32_bf16 v[0:3], a[196:199], a[120:123], v[0:3]
    buffer_load_dwordx4 a[156:159], v127, s[4:7], s98 offen sc1
    v_mfma_f32_16x16x32_bf16 v[4:7], a[200:203], a[120:123], v[4:7]
    ds_read_b128 v[100:103], v129 offset:256
    v_mfma_f32_16x16x32_bf16 v[8:11], a[204:207], a[120:123], v[8:11]
    s_add_u32 s24, s16, 1
    v_mfma_f32_16x16x32_bf16 v[12:15], a[208:211], a[120:123], v[12:15]
    s_and_b32 s24, s24, 3
    v_mfma_f32_16x16x32_bf16 v[16:19], a[212:215], a[120:123], v[16:19]
    s_mul_i32 s24, s24, 15360
    s_waitcnt vmcnt(8)
    v_mfma_f32_16x16x32_bf16 v[0:3], a[216:219], a[124:127], v[0:3]
    buffer_load_dwordx4 a[48:51], v124, s[4:7], s99 offen sc1
    v_mfma_f32_16x16x32_bf16 v[4:7], a[220:223], a[124:127], v[4:7]
    v_add_u32 v80, s24, v255
    v_mfma_f32_16x16x32_bf16 v[8:11], a[224:227], a[124:127], v[8:11]
    s_add_u32 s24, s16, 2
    v_mfma_f32_16x16x32_bf16 v[12:15], a[228:231], a[124:127], v[12:15]
    s_and_b32 s24, s24, 3
    v_mfma_f32_16x16x32_bf16 v[16:19], a[232:235], a[124:127], v[16:19]
    s_mul_i32 s24, s24, 15360
    s_waitcnt vmcnt(8)
    v_mfma_f32_16x16x32_bf16 v[20:23], v[240:243], a[128:131], v[20:23]
    buffer_load_dwordx4 a[52:55], v125, s[4:7], s99 offen sc1
    v_mfma_f32_16x16x32_bf16 v[24:27], a[160:163], a[128:131], v[24:27]
    v_add_u32 v81, s24, v255
    v_mfma_f32_16x16x32_bf16 v[28:31], a[164:167], a[128:131], v[28:31]
    s_add_u32 s24, s16, 3
    v_mfma_f32_16x16x32_bf16 v[32:35], a[168:171], a[128:131], v[32:35]
    s_and_b32 s24, s24, 3
    v_mfma_f32_16x16x32_bf16 v[36:39], a[172:175], a[128:131], v[36:39]
    s_mul_i32 s24, s24, 15360
    s_waitcnt vmcnt(8)
    v_mfma_f32_16x16x32_bf16 v[20:23], a[176:179], a[132:135], v[20:23]
    s_add_u32 s25, s95, 30572544
    buffer_load_dword v251, v250, s[4:7], s25 offen sc1
    buffer_load_dwordx4 a[56:59], v126, s[4:7], s99 offen sc1
    v_mfma_f32_16x16x32_bf16 v[24:27], a[180:183], a[132:135], v[24:27]
    v_add_u32 v82, s24, v255
    v_mfma_f32_16x16x32_bf16 v[28:31], a[184:187], a[132:135], v[28:31]
    s_add_u32 s24, s16, 4
    v_mfma_f32_16x16x32_bf16 v[32:35], a[188:191], a[132:135], v[32:35]
    s_and_b32 s24, s24, 3
    v_mfma_f32_16x16x32_bf16 v[36:39], a[192:195], a[132:135], v[36:39]
    s_mul_i32 s24, s24, 15360
    s_waitcnt vmcnt(9)
    v_mfma_f32_16x16x32_bf16 v[20:23], a[196:199], a[136:139], v[20:23]
    buffer_load_dwordx4 a[60:63], v127, s[4:7], s99 offen sc1
    v_mfma_f32_16x16x32_bf16 v[24:27], a[200:203], a[136:139], v[24:27]
    v_add_u32 v83, s24, v255
    v_mfma_f32_16x16x32_bf16 v[28:31], a[204:207], a[136:139], v[28:31]
    v_and_b32 v128, 15, v254
    v_mfma_f32_16x16x32_bf16 v[32:35], a[208:211], a[136:139], v[32:35]
    v_mul_u32_u24 v128, 1280, v128
    v_mfma_f32_16x16x32_bf16 v[36:39], a[212:215], a[136:139], v[36:39]
    v_lshrrev_b32 v129, 4, v254
    s_waitcnt vmcnt(9)
    v_mfma_f32_16x16x32_bf16 v[20:23], a[216:219], a[140:143], v[20:23]
    v_lshl_add_u32 v129, v129, 3, v128
    v_mfma_f32_16x16x32_bf16 v[24:27], a[220:223], a[140:143], v[24:27]
    v_and_b32 v130, 48, v254
    v_mfma_f32_16x16x32_bf16 v[28:31], a[224:227], a[140:143], v[28:31]
    v_add_u32 v128, v130, v128
    v_mfma_f32_16x16x32_bf16 v[32:35], a[228:231], a[140:143], v[32:35]
    s_lshl_b32 s26, s22, 1
    v_mfma_f32_16x16x32_bf16 v[36:39], a[232:235], a[140:143], v[36:39]
    s_add_u32 s26, s26, s16
    s_waitcnt vmcnt(8)
    v_mfma_f32_16x16x32_bf16 v[40:43], v[240:243], a[144:147], v[40:43]
    s_mul_i32 s26, s26, 20480
    v_mfma_f32_16x16x32_bf16 v[44:47], a[160:163], a[144:147], v[44:47]
    s_mul_i32 s24, s20, 160
    v_mfma_f32_16x16x32_bf16 v[48:51], a[164:167], a[144:147], v[48:51]
    s_add_u32 s26, s26, s24
    v_mfma_f32_16x16x32_bf16 v[52:55], a[168:171], a[144:147], v[52:55]
    s_mov_b32 s28, s26
    v_mfma_f32_16x16x32_bf16 v[56:59], a[172:175], a[144:147], v[56:59]
    v_accvgpr_read_b32 v131, a240
    s_waitcnt vmcnt(7)
    v_mfma_f32_16x16x32_bf16 v[40:43], a[176:179], a[148:151], v[40:43]
    v_lshlrev_b32 v104, 16, v131
    v_mfma_f32_16x16x32_bf16 v[44:47], a[180:183], a[148:151], v[44:47]
    v_and_b32 v105, 0xffff0000, v131
    v_mfma_f32_16x16x32_bf16 v[48:51], a[184:187], a[148:151], v[48:51]
    v_accvgpr_read_b32 v131, a241
    v_mfma_f32_16x16x32_bf16 v[52:55], a[188:191], a[148:151], v[52:55]
    v_lshlrev_b32 v106, 16, v131
    v_mfma_f32_16x16x32_bf16 v[56:59], a[192:195], a[148:151], v[56:59]
    v_and_b32 v107, 0xffff0000, v131
    s_waitcnt vmcnt(6)
    v_mfma_f32_16x16x32_bf16 v[40:43], a[196:199], a[152:155], v[40:43]
    v_accvgpr_read_b32 v131, a242
    v_mfma_f32_16x16x32_bf16 v[44:47], a[200:203], a[152:155], v[44:47]
    v_lshlrev_b32 v108, 16, v131
    v_mfma_f32_16x16x32_bf16 v[48:51], a[204:207], a[152:155], v[48:51]
    v_and_b32 v109, 0xffff0000, v131
    v_mfma_f32_16x16x32_bf16 v[52:55], a[208:211], a[152:155], v[52:55]
    v_accvgpr_read_b32 v131, a243
    v_mfma_f32_16x16x32_bf16 v[56:59], a[212:215], a[152:155], v[56:59]
    v_lshlrev_b32 v110, 16, v131
    s_waitcnt vmcnt(5)
    v_mfma_f32_16x16x32_bf16 v[40:43], a[216:219], a[156:159], v[40:43]
    v_and_b32 v111, 0xffff0000, v131
    v_mfma_f32_16x16x32_bf16 v[44:47], a[220:223], a[156:159], v[44:47]
    v_accvgpr_read_b32 v131, a244
    v_mfma_f32_16x16x32_bf16 v[48:51], a[224:227], a[156:159], v[48:51]
    v_lshlrev_b32 v112, 16, v131
    v_mfma_f32_16x16x32_bf16 v[52:55], a[228:231], a[156:159], v[52:55]
    v_and_b32 v113, 0xffff0000, v131
    v_mfma_f32_16x16x32_bf16 v[56:59], a[232:235], a[156:159], v[56:59]
    v_accvgpr_read_b32 v131, a245
    s_waitcnt vmcnt(4)
    v_mfma_f32_16x16x32_bf16 v[60:63], v[240:243], a[48:51], v[60:63]
    v_lshlrev_b32 v114, 16, v131
    v_mfma_f32_16x16x32_bf16 v[64:67], a[160:163], a[48:51], v[64:67]
    v_and_b32 v115, 0xffff0000, v131
    v_mfma_f32_16x16x32_bf16 v[68:71], a[164:167], a[48:51], v[68:71]
    v_accvgpr_read_b32 v131, a246
    v_mfma_f32_16x16x32_bf16 v[72:75], a[168:171], a[48:51], v[72:75]
    v_lshlrev_b32 v116, 16, v131
    v_mfma_f32_16x16x32_bf16 v[76:79], a[172:175], a[48:51], v[76:79]
    v_and_b32 v117, 0xffff0000, v131
    s_waitcnt vmcnt(3)
    v_mfma_f32_16x16x32_bf16 v[60:63], a[176:179], a[52:55], v[60:63]
    v_accvgpr_read_b32 v131, a247
    v_mfma_f32_16x16x32_bf16 v[64:67], a[180:183], a[52:55], v[64:67]
    v_lshlrev_b32 v118, 16, v131
    v_mfma_f32_16x16x32_bf16 v[68:71], a[184:187], a[52:55], v[68:71]
    v_and_b32 v119, 0xffff0000, v131
    v_mfma_f32_16x16x32_bf16 v[72:75], a[188:191], a[52:55], v[72:75]
    v_accvgpr_read_b32 v131, a248
    v_mfma_f32_16x16x32_bf16 v[76:79], a[192:195], a[52:55], v[76:79]
    v_lshlrev_b32 v120, 16, v131
    s_waitcnt vmcnt(1)
    v_mfma_f32_16x16x32_bf16 v[60:63], a[196:199], a[56:59], v[60:63]
    v_and_b32 v121, 0xffff0000, v131
    v_mfma_f32_16x16x32_bf16 v[64:67], a[200:203], a[56:59], v[64:67]
    v_accvgpr_read_b32 v131, a249
    v_mfma_f32_16x16x32_bf16 v[68:71], a[204:207], a[56:59], v[68:71]
    s_add_u32 s96, s96, 2048
    s_add_u32 s97, s97, 2048
    s_add_u32 s98, s98, 2048
    s_add_u32 s99, s99, 2048
    v_cmp_ne_u32 vcc, s64, v251
    s_cbranch_vccz L_pdone_hh2
    s_mov_b32 s65, 0x20000
L_poll_hh2:
    buffer_load_dword v244, v250, s[4:7], s25 offen sc1
    s_waitcnt vmcnt(0)
    v_cmp_ne_u32 vcc, s64, v244
    s_cbranch_vccz L_pdone_hh2
    s_sub_u32 s65, s65, 1
    s_cbranch_scc0 L_poll_hh2
L_pdone_hh2:
    buffer_load_dwordx4 a[64:67], v124, s[4:7], s96 offen sc1
    buffer_load_dwordx4 a[68:71], v125, s[4:7], s96 offen sc1
    buffer_load_dwordx4 a[72:75], v126, s[4:7], s96 offen sc1
    buffer_load_dwordx4 a[76:79], v127, s[4:7], s96 offen sc1
    buffer_load_dwordx4 a[80:83], v124, s[4:7], s97 offen sc1
    buffer_load_dwordx4 a[84:87], v125, s[4:7], s97 offen sc1
    v_mfma_f32_16x16x32_bf16 v[72:75], a[208:211], a[56:59], v[72:75]
    v_lshlrev_b32 v122, 16, v131
    v_mfma_f32_16x16x32_bf16 v[76:79], a[212:215], a[56:59], v[76:79]
    v_and_b32 v123, 0xffff0000, v131
    s_waitcnt vmcnt(6)
    v_mfma_f32_16x16x32_bf16 v[60:63], a[216:219], a[60:63], v[60:63]
    buffer_load_dwordx4 a[88:91], v126, s[4:7], s97 offen sc1
    v_mfma_f32_16x16x32_bf16 v[64:67], a[220:223], a[60:63], v[64:67]
    v_mfma_f32_16x16x32_bf16 v[68:71], a[224:227], a[60:63], v[68:71]
    v_mfma_f32_16x16x32_bf16 v[72:75], a[228:231], a[60:63], v[72:75]
    v_mfma_f32_16x16x32_bf16 v[76:79], a[232:235], a[60:63], v[76:79]
    buffer_load_dwordx4 a[44:47], v255, s[4:7], s74 offen offset:3072 sc1
    s_waitcnt vmcnt(7)
    v_mfma_f32_16x16x32_bf16 v[0:3], a[236:239], a[64:67], v[0:3]
    buffer_load_dwordx4 a[92:95], v127, s[4:7], s97 offen sc1
    v_mfma_f32_16x16x32_bf16 v[4:7], v[132:135], a[64:67], v[4:7]
    v_mfma_f32_16x16x32_bf16 v[8:11], v[136:139], a[64:67], v[8:11]
    v_mfma_f32_16x16x32_bf16 v[12:15], v[140:143], a[64:67], v[12:15]
    v_mfma_f32_16x16x32_bf16 v[16:19], v[144:147], a[64:67], v[16:19]
    s_waitcnt vmcnt(7)
    v_mfma_f32_16x16x32_bf16 v[0:3], v[148:151], a[68:71], v[0:3]
    buffer_load_dwordx4 a[96:99], v124, s[4:7], s98 offen sc1
    v_mfma_f32_16x16x32_bf16 v[4:7], v[152:155], a[68:71], v[4:7]
    v_mfma_f32_16x16x32_bf16 v[8:11], v[156:159], a[68:71], v[8:11]
    v_mfma_f32_16x16x32_bf16 v[12:15], a[0:3], a[68:71], v[12:15]
    v_mfma_f32_16x16x32_bf16 v[16:19], a[4:7], a[68:71], v[16:19]
    s_waitcnt vmcnt(7)
    v_mfma_f32_16x16x32_bf16 v[0:3], a[8:11], a[72:75], v[0:3]
    buffer_load_dwordx4 a[100:103], v125, s[4:7], s98 offen sc1
    v_mfma_f32_16x16x32_bf16 v[4:7], a[12:15], a[72:75], v[4:7]
    v_mfma_f32_16x16x32_bf16 v[8:11], a[16:19], a[72:75], v[8:11]
    v_mfma_f32_16x16x32_bf16 v[12:15], a[20:23], a[72:75], v[12:15]
    v_mfma_f32_16x16x32_bf16 v[16:19], a[24:27], a[72:75], v[16:19]
    s_waitcnt vmcnt(7)
    v_mfma_f32_16x16x32_bf16 v[0:3], a[28:31], a[76:79], v[0:3]
    buffer_load_dwordx4 a[104:107], v126, s[4:7], s98 offen sc1
    v_mfma_f32_16x16x32_bf16 v[4:7], a[32:35], a[76:79], v[4:7]
    v_mfma_f32_16x16x32_bf16 v[8:11], a[36:39], a[76:79], v[8:11]
    v_mfma_f32_16x16x32_bf16 v[12:15], a[40:43], a[76:79], v[12:15]
    s_waitcnt vmcnt(4)
    v_mfma_f32_16x16x32_bf16 v[16:19], a[44:47], a[76:79], v[16:19]
    v_mfma_f32_16x16x32_bf16 v[20:23], a[236:239], a[80:83], v[20:23]
    buffer_load_dwordx4 a[108:111], v127, s[4:7], s98 offen sc1
    v_mfma_f32_16x16x32_bf16 v[24:27], v[132:135], a[80:83], v[24:27]
    v_mfma_f32_16x16x32_bf16 v[28:31], v[136:139], a[80:83], v[28:31]
    v_mfma_f32_16x16x32_bf16 v[32:35], v[140:143], a[80:83], v[32:35]
    ds_write_b128 v80, v[0:3] offset:0
    v_mfma_f32_16x16x32_bf16 v[36:39], v[144:147], a[80:83], v[36:39]
    ds_write_b128 v80, v[4:7] offset:1024
    v_mfma_f32_16x16x32_bf16 v[20:23], v[148:151], a[84:87], v[20:23]
    buffer_load_dwordx4 a[112:115], v124, s[4:7], s99 offen sc1
    ds_write_b128 v80, v[8:11] offset:2048
    v_mfma_f32_16x16x32_bf16 v[24:27], v[152:155], a[84:87], v[24:27]
    ds_write_b128 v80, v[12:15] offset:3072
    v_mfma_f32_16x16x32_bf16 v[28:31], v[156:159], a[84:87], v[28:31]
    ds_write_b128 v80, v[16:19] offset:4096
    v_mfma_f32_16x16x32_bf16 v[32:35], a[0:3], a[84:87], v[32:35]
    v_mfma_f32_16x16x32_bf16 v[36:39], a[4:7], a[84:87], v[36:39]
    v_mfma_f32_16x16x32_bf16 v[20:23], a[8:11], a[88:91], v[20:23]
    buffer_load_dwordx4 a[116:119], v125, s[4:7], s99 offen sc1
    v_mfma_f32_16x16x32_bf16 v[24:27], a[12:15], a[88:91], v[24:27]
    v_mfma_f32_16x16x32_bf16 v[28:31], a[16:19], a[88:91], v[28:31]
    v_mfma_f32_16x16x32_bf16 v[32:35], a[20:23], a[88:91], v[32:35]
    v_mfma_f32_16x16x32_bf16 v[36:39], a[24:27], a[88:91], v[36:39]
    s_waitcnt vmcnt(6)
    v_mfma_f32_16x16x32_bf16 v[20:23], a[28:31], a[92:95], v[20:23]
    buffer_load_dwordx4 a[120:123], v126, s[4:7], s99 offen sc1
    v_mfma_f32_16x16x32_bf16 v[24:27], a[32:35], a[92:95], v[24:27]
    v_mfma_f32_16x16x32_bf16 v[28:31], a[36:39], a[92:95], v[28:31]
    v_mfma_f32_16x16x32_bf16 v[32:35], a[40:43], a[92:95], v[32:35]
    v_mfma_f32_16x16x32_bf16 v[36:39], a[44:47], a[92:95], v[36:39]
    s_waitcnt vmcnt(6)
    v_mfma_f32_16x16x32_bf16 v[40:43], a[236:239], a[96:99], v[40:43]
    buffer_load_dwordx4 a[124:127], v127, s[4:7], s99 offen sc1
    v_mfma_f32_16x16x32_bf16 v[44:47], v[132:135], a[96:99], v[44:47]
    v_mfma_f32_16x16x32_bf16 v[48:51], v[136:139], a[96:99], v[48:51]
    v_mfma_f32_16x16x32_bf16 v[52:55], v[140:143], a[96:99], v[52:55]
    ds_write_b128 v81, v[20:23] offset:5120
    v_mfma_f32_16x16x32_bf16 v[56:59], v[144:147], a[96:99], v[56:59]
    ds_write_b128 v81, v[24:27] offset:6144
    s_waitcnt vmcnt(6)
    v_mfma_f32_16x16x32_bf16 v[40:43], v[148:151], a[100:103], v[40:43]
    ds_write_b128 v81, v[28:31] offset:7168
    v_mfma_f32_16x16x32_bf16 v[44:47], v[152:155], a[100:103], v[44:47]
    ds_write_b128 v81, v[32:35] offset:8192
    v_mfma_f32_16x16x32_bf16 v[48:51], v[156:159], a[100:103], v[48:51]
    ds_write_b128 v81, v[36:39] offset:9216
    v_mfma_f32_16x16x32_bf16 v[52:55], a[0:3], a[100:103], v[52:55]
    v_mfma_f32_16x16x32_bf16 v[56:59], a[4:7], a[100:103], v[56:59]
    s_waitcnt vmcnt(5)
    v_mfma_f32_16x16x32_bf16 v[40:43], a[8:11], a[104:107], v[40:43]
    v_mfma_f32_16x16x32_bf16 v[44:47], a[12:15], a[104:107], v[44:47]
    v_mfma_f32_16x16x32_bf16 v[48:51], a[16:19], a[104:107], v[48:51]
    v_mfma_f32_16x16x32_bf16 v[52:55], a[20:23], a[104:107], v[52:55]
    v_mfma_f32_16x16x32_bf16 v[56:59], a[24:27], a[104:107], v[56:59]
    s_waitcnt vmcnt(4)
    v_mfma_f32_16x16x32_bf16 v[40:43], a[28:31], a[108:111], v[40:43]
    v_mfma_f32_16x16x32_bf16 v[44:47], a[32:35], a[108:111], v[44:47]
    v_mfma_f32_16x16x32_bf16 v[48:51], a[36:39], a[108:111], v[48:51]
    v_mfma_f32_16x16x32_bf16 v[52:55], a[40:43], a[108:111], v[52:55]
    v_mfma_f32_16x16x32_bf16 v[56:59], a[44:47], a[108:111], v[56:59]
    s_waitcnt vmcnt(3)
    v_mfma_f32_16x16x32_bf16 v[60:63], a[236:239], a[112:115], v[60:63]
    v_mfma_f32_16x16x32_bf16 v[64:67], v[132:135], a[112:115], v[64:67]
    v_mfma_f32_16x16x32_bf16 v[68:71], v[136:139], a[112:115], v[68:71]
    v_mfma_f32_16x16x32_bf16 v[72:75], v[140:143], a[112:115], v[72:75]
    ds_write_b128 v82, v[40:43] offset:10240
    v_mfma_f32_16x16x32_bf16 v[76:79], v[144:147], a[112:115], v[76:79]
    ds_write_b128 v82, v[44:47] offset:11264
    s_waitcnt vmcnt(2)
    v_mfma_f32_16x16x32_bf16 v[60:63], v[148:151], a[116:119], v[60:63]
    ds_write_b128 v82, v[48:51] offset:12288
    v_mfma_f32_16x16x32_bf16 v[64:67], v[152:155], a[116:119], v[64:67]
    ds_write_b128 v82, v[52:55] offset:13312
    v_mfma_f32_16x16x32_bf16 v[68:71], v[156:159], a[116:119], v[68:71]
    ds_write_b128 v82, v[56:59] offset:14336
    s_waitcnt lgkmcnt(0)
    v_mfma_f32_16x16x32_bf16 v[72:75], a[0:3], a[116:119], v[72:75]
    s_barrier
    ds_read_b128 v[0:3], v83 offset:0
    v_mfma_f32_16x16x32_bf16 v[76:79], a[4:7], a[116:119], v[76:79]
    ds_read_b128 v[4:7], v83 offset:1024
    ds_read_b128 v[8:11], v83 offset:2048
    s_waitcnt vmcnt(1)
    v_mfma_f32_16x16x32_bf16 v[60:63], a[8:11], a[120:123], v[60:63]
    ds_read_b128 v[12:15], v83 offset:3072
    ds_read_b128 v[16:19], v83 offset:4096
    v_mfma_f32_16x16x32_bf16 v[64:67], a[12:15], a[120:123], v[64:67]
    ds_read_b128 v[20:23], v83 offset:5120
    ds_read_b128 v[24:27], v83 offset:6144
    v_mfma_f32_16x16x32_bf16 v[68:71], a[16:19], a[120:123], v[68:71]
    ds_read_b128 v[28:31], v83 offset:7168
    ds_read_b128 v[32:35], v83 offset:8192
    v_mfma_f32_16x16x32_bf16 v[72:75], a[20:23], a[120:123], v[72:75]
    ds_read_b128 v[36:39], v83 offset:9216
    ds_read_b128 v[40:43], v83 offset:10240
    v_mfma_f32_16x16x32_bf16 v[76:79], a[24:27], a[120:123], v[76:79]
    ds_read_b128 v[44:47], v83 offset:11264
    ds_read_b128 v[48:51], v83 offset:12288
    s_waitcnt vmcnt(0)
    v_mfma_f32_16x16x32_bf16 v[60:63], a[28:31], a[124:127], v[60:63]
    ds_read_b128 v[52:55], v83 offset:13312
    ds_read_b128 v[56:59], v83 offset:14336
    v_mfma_f32_16x16x32_bf16 v[64:67], a[32:35], a[124:127], v[64:67]
    v_mfma_f32_16x16x32_bf16 v[68:71], a[36:39], a[124:127], v[68:71]
    v_mfma_f32_16x16x32_bf16 v[72:75], a[40:43], a[124:127], v[72:75]
    v_mfma_f32_16x16x32_bf16 v[76:79], a[44:47], a[124:127], v[76:79]
    s_waitcnt lgkmcnt(9)
    v_pk_add_f32 v[0:1], v[0:1], v[20:21]
    v_pk_add_f32 v[2:3], v[2:3], v[22:23]
    s_waitcnt lgkmcnt(8)
    v_pk_add_f32 v[4:5], v[4:5], v[24:25]
    v_pk_add_f32 v[6:7], v[6:7], v[26:27]
    s_waitcnt lgkmcnt(7)
    v_pk_add_f32 v[8:9], v[8:9], v[28:29]
    v_pk_add_f32 v[10:11], v[10:11], v[30:31]
    s_waitcnt lgkmcnt(6)
    v_pk_add_f32 v[12:13], v[12:13], v[32:33]
    v_pk_add_f32 v[14:15], v[14:15], v[34:35]
    s_waitcnt lgkmcnt(5)
    v_pk_add_f32 v[16:17], v[16:17], v[36:37]
    v_pk_add_f32 v[18:19], v[18:19], v[38:39]
    v_pk_add_f32 v[60:61], v[60:61], v[0:1]
    v_pk_add_f32 v[62:63], v[62:63], v[2:3]
    v_pk_add_f32 v[64:65], v[64:65], v[4:5]
    v_pk_add_f32 v[66:67], v[66:67], v[6:7]
    v_pk_add_f32 v[68:69], v[68:69], v[8:9]
    v_pk_add_f32 v[70:71], v[70:71], v[10:11]
    v_pk_add_f32 v[72:73], v[72:73], v[12:13]
    v_pk_add_f32 v[74:75], v[74:75], v[14:15]
    v_pk_add_f32 v[76:77], v[76:77], v[16:17]
    v_pk_add_f32 v[78:79], v[78:79], v[18:19]
    s_waitcnt lgkmcnt(4)
    v_pk_add_f32 v[60:61], v[60:61], v[40:41]
    v_pk_add_f32 v[62:63], v[62:63], v[42:43]
    s_waitcnt lgkmcnt(3)
    v_pk_add_f32 v[64:65], v[64:65], v[44:45]
    v_pk_add_f32 v[66:67], v[66:67], v[46:47]
    s_waitcnt lgkmcnt(2)
    v_pk_add_f32 v[68:69], v[68:69], v[48:49]
    v_pk_add_f32 v[70:71], v[70:71], v[50:51]
    s_waitcnt lgkmcnt(1)
    v_pk_add_f32 v[72:73], v[72:73], v[52:53]
    v_pk_add_f32 v[74:75], v[74:75], v[54:55]
    s_waitcnt lgkmcnt(0)
    v_pk_add_f32 v[76:77], v[76:77], v[56:57]
    v_pk_add_f32 v[78:79], v[78:79], v[58:59]
    v_pk_fma_f32 v[60:61], v[60:61], v[84:85], v[104:105]
    v_cvt_pk_bf16_f32 v40, v60, v61
    v_pk_fma_f32 v[62:63], v[62:63], v[86:87], v[106:107]
    v_cvt_pk_bf16_f32 v41, v62, v63
    v_pk_fma_f32 v[64:65], v[64:65], v[88:89], v[108:109]
    v_cvt_pk_bf16_f32 v42, v64, v65
    v_pk_fma_f32 v[66:67], v[66:67], v[90:91], v[110:111]
    v_cvt_pk_bf16_f32 v43, v66, v67
    buffer_store_dwordx4 v[40:43], v128, s[12:15], s28 offen
    v_pk_fma_f32 v[68:69], v[68:69], v[92:93], v[112:113]
    v_cvt_pk_bf16_f32 v44, v68, v69
    v_pk_fma_f32 v[70:71], v[70:71], v[94:95], v[114:115]
    v_cvt_pk_bf16_f32 v45, v70, v71
    v_pk_fma_f32 v[72:73], v[72:73], v[96:97], v[116:117]
    v_cvt_pk_bf16_f32 v46, v72, v73
    v_pk_fma_f32 v[74:75], v[74:75], v[98:99], v[118:119]
    v_cvt_pk_bf16_f32 v47, v74, v75
    buffer_store_dwordx4 v[44:47], v128, s[12:15], s28 offen offset:64
    v_pk_fma_f32 v[76:77], v[76:77], v[100:101], v[120:121]
    v_cvt_pk_bf16_f32 v48, v76, v77
    v_pk_fma_f32 v[78:79], v[78:79], v[102:103], v[122:123]
    v_cvt_pk_bf16_f32 v49, v78, v79
    buffer_store_dwordx2 v[48:49], v129, s[12:15], s28 offen offset:128
    s_endpgm
L_neg_0:
    v_mov_b32 v184, 0xf149f2ca
    v_mov_b32 v185, 0xf149f2ca
    v_mov_b32 v186, 0xf149f2ca
    v_mov_b32 v187, 0xf149f2ca
    v_mov_b32 v188, 0xf149f2ca
    v_mov_b32 v189, 0xf149f2ca
    v_mov_b32 v190, 0xf149f2ca
    v_mov_b32 v191, 0xf149f2ca
    v_mov_b32 v192, 0xf149f2ca
    v_mov_b32 v193, 0xf149f2ca
    v_mov_b32 v194, 0xf149f2ca
    v_mov_b32 v195, 0xf149f2ca
    v_mov_b32 v196, 0xf149f2ca
    v_mov_b32 v197, 0xf149f2ca
    v_mov_b32 v198, 0xf149f2ca
    v_mov_b32 v199, 0xf149f2ca
    s_branch L_nret_0
L_zero_0_1:
    s_nop 7
    v_mov_b32 v184, 0
    v_mov_b32 v185, 0
    v_mov_b32 v186, 0
    v_mov_b32 v187, 0
    v_mov_b32 v188, 0
    v_mov_b32 v189, 0
    v_mov_b32 v190, 0
    v_mov_b32 v191, 0
    v_mov_b32 v192, 0
    v_mov_b32 v193, 0
    v_mov_b32 v194, 0
    v_mov_b32 v195, 0
    v_mov_b32 v196, 0
    v_mov_b32 v197, 0
    v_mov_b32 v198, 0
    v_mov_b32 v199, 0
    s_nop 1
    s_branch L_zret_0_1
L_zero_0_2:
    s_nop 7
    v_mov_b32 v184, 0
    v_mov_b32 v185, 0
    v_mov_b32 v186, 0
    v_mov_b32 v187, 0
    v_mov_b32 v188, 0
    v_mov_b32 v189, 0
    v_mov_b32 v190, 0
    v_mov_b32 v191, 0
    v_mov_b32 v192, 0
    v_mov_b32 v193, 0
    v_mov_b32 v194, 0
    v_mov_b32 v195, 0
    v_mov_b32 v196, 0
    v_mov_b32 v197, 0
    v_mov_b32 v198, 0
    v_mov_b32 v199, 0
    s_nop 1
    s_branch L_zret_0_2
L_zero_0_3:
    s_nop 7
    v_mov_b32 v184, 0
    v_mov_b32 v185, 0
    v_mov_b32 v186, 0
    v_mov_b32 v187, 0
    v_mov_b32 v188, 0
    v_mov_b32 v189, 0
    v_mov_b32 v190, 0
    v_mov_b32 v191, 0
    v_mov_b32 v192, 0
    v_mov_b32 v193, 0
    v_mov_b32 v194, 0
    v_mov_b32 v195, 0
    v_mov_b32 v196, 0
    v_mov_b32 v197, 0
    v_mov_b32 v198, 0
    v_mov_b32 v199, 0
    s_nop 1
    s_branch L_zret_0_3
L_zero_0_4:
    s_nop 7
    v_mov_b32 v184, 0
    v_mov_b32 v185, 0
    v_mov_b32 v186, 0
    v_mov_b32 v187, 0
    v_mov_b32 v188, 0
    v_mov_b32 v189, 0
    v_mov_b32 v190, 0
    v_mov_b32 v191, 0
    v_mov_b32 v192, 0
    v_mov_b32 v193, 0
    v_mov_b32 v194, 0
    v_mov_b32 v195, 0
    v_mov_b32 v196, 0
    v_mov_b32 v197, 0
    v_mov_b32 v198, 0
    v_mov_b32 v199, 0
    s_nop 1
    s_branch L_zret_0_4
L_zero_0_5:
    s_nop 7
    v_mov_b32 v184, 0
    v_mov_b32 v185, 0
    v_mov_b32 v186, 0
    v_mov_b32 v187, 0
    v_mov_b32 v188, 0
    v_mov_b32 v189, 0
    v_mov_b32 v190, 0
    v_mov_b32 v191, 0
    v_mov_b32 v192, 0
    v_mov_b32 v193, 0
    v_mov_b32 v194, 0
    v_mov_b32 v195, 0
    v_mov_b32 v196, 0
    v_mov_b32 v197, 0
    v_mov_b32 v198, 0
    v_mov_b32 v199, 0
    s_nop 1
    s_branch L_zret_0_5
L_zero_0_6:
    s_nop 7
    v_mov_b32 v184, 0
    v_mov_b32 v185, 0
    v_mov_b32 v186, 0
    v_mov_b32 v187, 0
    v_mov_b32 v188, 0
    v_mov_b32 v189, 0
    v_mov_b32 v190, 0
    v_mov_b32 v191, 0
    v_mov_b32 v192, 0
    v_mov_b32 v193, 0
    v_mov_b32 v194, 0
    v_mov_b32 v195, 0
    v_mov_b32 v196, 0
    v_mov_b32 v197, 0
    v_mov_b32 v198, 0
    v_mov_b32 v199, 0
    s_nop 1
    s_branch L_zret_0_6
L_zero_0_7:
    s_nop 7
    v_mov_b32 v184, 0
    v_mov_b32 v185, 0
    v_mov_b32 v186, 0
    v_mov_b32 v187, 0
    v_mov_b32 v188, 0
    v_mov_b32 v189, 0
    v_mov_b32 v190, 0
    v_mov_b32 v191, 0
    v_mov_b32 v192, 0
    v_mov_b32 v193, 0
    v_mov_b32 v194, 0
    v_mov_b32 v195, 0
    v_mov_b32 v196, 0
    v_mov_b32 v197, 0
    v_mov_b32 v198, 0
    v_mov_b32 v199, 0
    s_nop 1
    s_branch L_zret_0_7
L_neg_1:
    v_mov_b32 v184, 0xf149f2ca
    v_mov_b32 v185, 0xf149f2ca
    v_mov_b32 v186, 0xf149f2ca
    v_mov_b32 v187, 0xf149f2ca
    v_mov_b32 v188, 0xf149f2ca
    v_mov_b32 v189, 0xf149f2ca
    v_mov_b32 v190, 0xf149f2ca
    v_mov_b32 v191, 0xf149f2ca
    v_mov_b32 v192, 0xf149f2ca
    v_mov_b32 v193, 0xf149f2ca
    v_mov_b32 v194, 0xf149f2ca
    v_mov_b32 v195, 0xf149f2ca
    v_mov_b32 v196, 0xf149f2ca
    v_mov_b32 v197, 0xf149f2ca
    v_mov_b32 v198, 0xf149f2ca
    v_mov_b32 v199, 0xf149f2ca
    s_branch L_nret_1
L_zero_1_1:
    s_nop 7
    v_mov_b32 v184, 0
    v_mov_b32 v185, 0
    v_mov_b32 v186, 0
    v_mov_b32 v187, 0
    v_mov_b32 v188, 0
    v_mov_b32 v189, 0
    v_mov_b32 v190, 0
    v_mov_b32 v191, 0
    v_mov_b32 v192, 0
    v_mov_b32 v193, 0
    v_mov_b32 v194, 0
    v_mov_b32 v195, 0
    v_mov_b32 v196, 0
    v_mov_b32 v197, 0
    v_mov_b32 v198, 0
    v_mov_b32 v199, 0
    s_nop 1
    s_branch L_zret_1_1
L_zero_1_2:
    s_nop 7
    v_mov_b32 v184, 0
    v_mov_b32 v185, 0
    v_mov_b32 v186, 0
    v_mov_b32 v187, 0
    v_mov_b32 v188, 0
    v_mov_b32 v189, 0
    v_mov_b32 v190, 0
    v_mov_b32 v191, 0
    v_mov_b32 v192, 0
    v_mov_b32 v193, 0
    v_mov_b32 v194, 0
    v_mov_b32 v195, 0
    v_mov_b32 v196, 0
    v_mov_b32 v197, 0
    v_mov_b32 v198, 0
    v_mov_b32 v199, 0
    s_nop 1
    s_branch L_zret_1_2
L_zero_1_3:
    s_nop 7
    v_mov_b32 v184, 0
    v_mov_b32 v185, 0
    v_mov_b32 v186, 0
    v_mov_b32 v187, 0
    v_mov_b32 v188, 0
    v_mov_b32 v189, 0
    v_mov_b32 v190, 0
    v_mov_b32 v191, 0
    v_mov_b32 v192, 0
    v_mov_b32 v193, 0
    v_mov_b32 v194, 0
    v_mov_b32 v195, 0
    v_mov_b32 v196, 0
    v_mov_b32 v197, 0
    v_mov_b32 v198, 0
    v_mov_b32 v199, 0
    s_nop 1
    s_branch L_zret_1_3
L_zero_1_4:
    s_nop 7
    v_mov_b32 v184, 0
    v_mov_b32 v185, 0
    v_mov_b32 v186, 0
    v_mov_b32 v187, 0
    v_mov_b32 v188, 0
    v_mov_b32 v189, 0
    v_mov_b32 v190, 0
    v_mov_b32 v191, 0
    v_mov_b32 v192, 0
    v_mov_b32 v193, 0
    v_mov_b32 v194, 0
    v_mov_b32 v195, 0
    v_mov_b32 v196, 0
    v_mov_b32 v197, 0
    v_mov_b32 v198, 0
    v_mov_b32 v199, 0
    s_nop 1
    s_branch L_zret_1_4
L_zero_1_5:
    s_nop 7
    v_mov_b32 v184, 0
    v_mov_b32 v185, 0
    v_mov_b32 v186, 0
    v_mov_b32 v187, 0
    v_mov_b32 v188, 0
    v_mov_b32 v189, 0
    v_mov_b32 v190, 0
    v_mov_b32 v191, 0
    v_mov_b32 v192, 0
    v_mov_b32 v193, 0
    v_mov_b32 v194, 0
    v_mov_b32 v195, 0
    v_mov_b32 v196, 0
    v_mov_b32 v197, 0
    v_mov_b32 v198, 0
    v_mov_b32 v199, 0
    s_nop 1
    s_branch L_zret_1_5
L_zero_1_6:
    s_nop 7
    v_mov_b32 v184, 0
    v_mov_b32 v185, 0
    v_mov_b32 v186, 0
    v_mov_b32 v187, 0
    v_mov_b32 v188, 0
    v_mov_b32 v189, 0
    v_mov_b32 v190, 0
    v_mov_b32 v191, 0
    v_mov_b32 v192, 0
    v_mov_b32 v193, 0
    v_mov_b32 v194, 0
    v_mov_b32 v195, 0
    v_mov_b32 v196, 0
    v_mov_b32 v197, 0
    v_mov_b32 v198, 0
    v_mov_b32 v199, 0
    s_nop 1
    s_branch L_zret_1_6
L_zero_1_7:
    s_nop 7
    v_mov_b32 v184, 0
    v_mov_b32 v185, 0
    v_mov_b32 v186, 0
    v_mov_b32 v187, 0
    v_mov_b32 v188, 0
    v_mov_b32 v189, 0
    v_mov_b32 v190, 0
    v_mov_b32 v191, 0
    v_mov_b32 v192, 0
    v_mov_b32 v193, 0
    v_mov_b32 v194, 0
    v_mov_b32 v195, 0
    v_mov_b32 v196, 0
    v_mov_b32 v197, 0
    v_mov_b32 v198, 0
    v_mov_b32 v199, 0
    s_nop 1
    s_branch L_zret_1_7
L_untag:
    s_load_dwordx2 s[32:33], s[0:1], 80
    s_mov_b32 s34, 256
    s_mov_b32 s35, 0x20000
    v_lshlrev_b32 v0, 7, v254
    s_mov_b32 s24, 31096832
    buffer_load_dword v1, v0, s[4:7], s24 offen sc1
    s_add_u32 s24, s24, 8192
    buffer_load_dword v2, v0, s[4:7], s24 offen sc1
    s_add_u32 s24, s24, 8192
    buffer_load_dword v3, v0, s[4:7], s24 offen sc1
    s_add_u32 s24, s24, 8192
    buffer_load_dword v4, v0, s[4:7], s24 offen sc1
    s_add_u32 s24, s24, 8192
    s_waitcnt vmcnt(3)
    v_xor_b32 v1, s64, v1
    s_waitcnt vmcnt(2)
    v_xor_b32 v2, s64, v2
    s_waitcnt vmcnt(1)
    v_xor_b32 v3, s64, v3
    s_waitcnt vmcnt(0)
    v_xor_b32 v4, s64, v4
    v_or3_b32 v1, v1, v2, v3
    v_or_b32 v1, v1, v4
    v_cmp_ne_u32 vcc, 0, v1
    s_waitcnt vmcnt(0) lgkmcnt(0)
    s_cbranch_vccnz L_untag_done
    buffer_store_dword v1, off, s[32:35], 0 sc1
    s_branch L_untag_done
L_main_end:
    s_endpgm
.section .rodata,"a"
.p2align 6
.amdhsa_kernel adaLN_cond__sliding_block__glu_gated_geglu__prompt_kernel
  .amdhsa_next_free_vgpr 512
  .amdhsa_next_free_sgpr 102
  .amdhsa_accum_offset 256
  .amdhsa_group_segment_fixed_size 0
  .amdhsa_kernarg_size 96
  .amdhsa_user_sgpr_count 2
  .amdhsa_user_sgpr_kernarg_segment_ptr 1
  .amdhsa_system_sgpr_workgroup_id_x 1
  .amdhsa_float_denorm_mode_32 3
.end_amdhsa_kernel
```
